```python
import torch

def _softmax(x, axis=-1):
    return torch.softmax(x, dim=axis)
def _gelu(x):
    return torch.nn.functional.gelu(x, approximate="tanh")
def _silu(x):
    return torch.nn.functional.silu(x)
def _sigmoid(x):
    return torch.sigmoid(x)
def _layernorm(x, axis=-1, eps=1e-5):
    m = x.mean(dim=axis, keepdim=True)
    v = x.var(dim=axis, keepdim=True, unbiased=False)
    return (x - m) / torch.sqrt(v + eps)
def _scatter_add(tgt, idx, src, axis=0):
    return tgt.clone().index_add_(axis, idx, src)
def _segment_sum(src, seg, n):
    out = torch.zeros((n,) + src.shape[1:], dtype=src.dtype)
    return out.index_add_(0, seg, src)
def _pad(x, pw):
    flat = tuple(v for pair in reversed(pw) for v in pair)
    return torch.nn.functional.pad(x, flat)

kernel_name = 'sequential_preLN__linear_kernel_hedgehog__glu_gated_reglu__prompt'

def setup_inputs():

    _w = (lambda a: (lambda t: t.to(torch.bfloat16) if t.is_floating_point() else t)(torch.as_tensor(a)))
    def _A_setup():
        B, S, D, H = 1, 2048, 640, 32
        Dh = D // H
        return {
            "x": _w((lambda *s: torch.randn(*s, dtype=torch.bfloat16) * 0.05)(B, S, D)),
            "wqkv": _w((lambda *s: torch.randn(*s, dtype=torch.bfloat16) * 0.2)(D, 3 * D)),
            "w_phi": _w((lambda *s: torch.randn(*s, dtype=torch.bfloat16) * 0.2)(H, Dh, Dh) * (Dh ** -0.5)),
            "wo": _w((lambda *s: torch.randn(*s, dtype=torch.bfloat16) * 0.05)(D, D)),
        }
    _A_in = _A_setup()

    def _B_setup():
        B, S, D, F = 1, 2048, 640, 1536
        return {
            "x": _w((lambda *s: torch.randn(*s, dtype=torch.bfloat16) * 0.05)(B, S, D)),
            "W_gate": _w((lambda *s: torch.randn(*s, dtype=torch.bfloat16) * 0.4)(D, F) * (2.0 / D) ** 0.5),
            "W_up": _w((lambda *s: torch.randn(*s, dtype=torch.bfloat16) * 0.4)(D, F) * (2.0 / D) ** 0.5),
            "W_down": _w((lambda *s: torch.randn(*s, dtype=torch.bfloat16) * 0.4)(F, D) * (1.0 / F) ** 0.5),
        }
    _B_in = _B_setup()

    return {
        "A_x": _A_in["x"],
        "A_wqkv": _A_in["wqkv"],
        "A_w_phi": _A_in["w_phi"],
        "A_wo": _A_in["wo"],
        "B_x": _B_in["x"],
        "B_W_gate": _B_in["W_gate"],
        "B_W_up": _B_in["W_up"],
        "B_W_down": _B_in["W_down"],
    }

def reference(A_x, A_wqkv, A_w_phi, A_wo, B_x, B_W_gate, B_W_up, B_W_down):
    def _A_ref(x, wqkv, w_phi, wo):
        B, S, D = x.shape
        H = 32; Dh = D // H
        qkv = (lambda x, *d: x.permute(*d))((x @ wqkv).reshape(B, S, 3, H, Dh), 2, 0, 3, 1, 4)
        q, k, v = qkv[0], qkv[1], qkv[2]
        pq = torch.einsum("bhsd,hdf->bhsf", q, w_phi)
        pk = torch.einsum("bhsd,hdf->bhsf", k, w_phi)
        phi_q = torch.concatenate([_softmax(pq, axis=-1), _softmax(-pq, axis=-1)], axis=-1)
        phi_k = torch.concatenate([_softmax(pk, axis=-1), _softmax(-pk, axis=-1)], axis=-1)
        kv = torch.einsum("bhsf,bhsd->bhfd", phi_k, v)
        z  = torch.einsum("bhsf->bhf", phi_k)
        num = torch.einsum("bhqf,bhfd->bhqd", phi_q, kv)
        den = torch.einsum("bhqf,bhf->bhq", phi_q, z)[..., None] + 1e-6
        o = num / den
        return (lambda x, *d: x.permute(*d))(o, 0, 2, 1, 3).reshape(B, S, D) @ wo

    def _B_ref(x, W_gate, W_up, W_down):
        gate = torch.einsum("bsd,df->bsf", x, W_gate)
        up = torch.einsum("bsd,df->bsf", x, W_up)
        gate = gate * (lambda x, dt: x.to(dt))(gate > 0, gate.dtype)
        h = gate * up
        return torch.einsum("bsf,fd->bsd", h, W_down)

    x = A_x
    h = x + _A_ref(_layernorm(x, axis=-1), A_wqkv, A_w_phi, A_wo)
    h2 = h + _B_ref(_layernorm(h, axis=-1), B_W_gate, B_W_up, B_W_down)
    return h2
```

```asm
; @launch grid=(256,1,1) block=(512,1,1) lds=163840
.amdgcn_target "amdgcn-amd-amdhsa--gfx950"
.text
.globl sequential_preLN__linear_kernel_hedgehog__glu_gated_reglu__prompt_kernel
.p2align 8
.type sequential_preLN__linear_kernel_hedgehog__glu_gated_reglu__prompt_kernel,@function
sequential_preLN__linear_kernel_hedgehog__glu_gated_reglu__prompt_kernel:
  s_cmp_ge_u32 s2, 256
  s_cbranch_scc1 sequential_preLN__linear_kernel_hedgehog__glu_gated_reglu__prompt_kernel_end
  v_and_b32 v3, 0xff, v0
  v_cmp_gt_u32 vcc, 64, v3
  s_nop 0
  s_and_saveexec_b64 s[4:5], vcc
  s_cbranch_execz Lcp0_1
  s_getpc_b64 s[6:7]
sequential_preLN__linear_kernel_hedgehog__glu_gated_reglu__prompt_kernel_pc0:
  v_lshlrev_b32 v4, 7, v3
  v_mov_b32 v5, sequential_preLN__linear_kernel_hedgehog__glu_gated_reglu__prompt_kernel_loader-sequential_preLN__linear_kernel_hedgehog__glu_gated_reglu__prompt_kernel_pc0
  v_cmp_le_u32 vcc, 256, v0
  s_nop 1
  v_cndmask_b32 v5, 0, v5, vcc
  v_add_u32 v4, v4, v5
  global_load_dword v255, v4, s[6:7]
Lcp0_1:
  s_mov_b64 exec, s[4:5]
  s_load_dwordx16 s[60:75], s[0:1], 0
  s_load_dwordx4 s[76:79], s[0:1], 64
  s_load_dwordx2 s[80:81], s[0:1], 80
  v_lshrrev_b32 v2, 6, v0
  v_and_b32 v1, 63, v0
  v_readfirstlane_b32 s3, v2
  s_and_b32 s4, s2, 7
  s_lshl_b32 s4, s4, 1
  s_bfe_u32 s5, s2, 0x10003
  s_add_u32 s4, s4, s5
  s_lshr_b32 s5, s2, 4
  s_xor_b32 s6, s5, 1
  s_and_b32 s7, s5, 1
  s_lshr_b32 s24, s5, 1
  s_mov_b32 s25, 0
  s_waitcnt lgkmcnt(0)
  s_mov_b32 s8, s60
  s_mov_b32 s9, s61
  s_mov_b32 s10, 0x280000
  s_mov_b32 s11, 0x20000
  s_mov_b32 s12, s62
  s_mov_b32 s13, s63
  s_mov_b32 s14, 0x258000
  s_mov_b32 s15, 0x20000
  s_mov_b32 s16, s64
  s_mov_b32 s17, s65
  s_mov_b32 s18, 0x6400
  s_mov_b32 s19, 0x20000
  s_mov_b32 s20, s80
  s_mov_b32 s21, s81
  s_mov_b32 s22, 0x10000000
  s_mov_b32 s23, 0x20000
  s_mov_b32 s28, s78
  s_mov_b32 s29, s79
  s_mov_b32 s30, 0x100
  s_mov_b32 s31, 0x20000
  s_cmp_ge_u32 s3, 4
  s_cbranch_scc1 sequential_preLN__linear_kernel_hedgehog__glu_gated_reglu__prompt_kernel_loader
  s_lshr_b32 s26, s3, 1
  s_and_b32 s27, s3, 1
  s_lshl_b32 s34, s4, 7
  s_lshl_b32 s35, s5, 3
  s_add_u32 s34, s34, s35
  s_lshl_b32 s35, s3, 1
  s_add_u32 s34, s34, s35
  s_mul_i32 s45, s34, 1280
  v_lshrrev_b32 v2, 5, v1
  v_mul_u32_u24 v2, 1280, v2
  v_and_b32 v3, 31, v1
  v_lshl_add_u32 v2, v3, 4, v2
  v_mov_b32 v200, 0
  v_mov_b32 v201, 0
  v_mov_b32 v202, 0
  v_mov_b32 v203, 0
  buffer_load_dwordx4 v[192:195], v2, s[8:11], s45 offen
  buffer_load_dwordx4 v[196:199], v2, s[8:11], s45 offen offset:512
  s_mov_b32 exec_lo, 0xffff
  s_mov_b32 exec_hi, 0xffff
  buffer_load_dwordx4 v[200:203], v2, s[8:11], s45 offen offset:1024
  s_mov_b64 exec, -1
  s_lshl_b32 s45, s34, 3
  s_add_u32 s45, s45, 22282240
  v_and_b32 v2, 31, v1
  v_lshrrev_b32 v3, 5, v1
  s_lshl_b32 s34, s26, 6
  v_add_u32 v4, s34, v2
  v_lshlrev_b32 v4, 7, v4
  s_lshl_b32 s35, s27, 12
  v_add_u32 v4, s35, v4
  v_xor_b32 v7, 0x1000, v4
  v_bfe_u32 v5, v2, 1, 3
  v_xor_b32 v5, v5, v3
  v_xor_b32 v6, 0, v5
  v_lshl_add_u32 v112, v6, 4, v4
  v_lshl_add_u32 v116, v6, 4, v7
  v_xor_b32 v6, 2, v5
  v_lshl_add_u32 v113, v6, 4, v4
  v_lshl_add_u32 v117, v6, 4, v7
  v_xor_b32 v6, 4, v5
  v_lshl_add_u32 v114, v6, 4, v4
  v_lshl_add_u32 v118, v6, 4, v7
  v_xor_b32 v6, 6, v5
  v_lshl_add_u32 v115, v6, 4, v4
  v_lshl_add_u32 v119, v6, 4, v7
  v_lshrrev_b32 v4, 4, v1
  v_bfe_u32 v5, v1, 2, 2
  v_and_b32 v6, 3, v1
  v_and_b32 v7, 1, v4
  v_lshlrev_b32 v7, 1, v7
  v_lshrrev_b32 v8, 1, v6
  v_add_u32 v7, v7, v8
  v_lshlrev_b32 v7, 3, v7
  v_and_b32 v8, 1, v6
  v_cmp_eq_u32 vcc, 1, v8
  v_lshrrev_b32 v9, 1, v4
  v_lshlrev_b32 v9, 3, v9
  v_add_u32 v9, v9, v5
  v_lshlrev_b32 v9, 8, v9
  v_lshlrev_b32 v10, 2, v5
  s_cmp_eq_u32 s27, 0
  s_mov_b32 s34, 0x18070605
  s_cselect_b32 s34, 0x3020100, s34
  s_mov_b32 s35, 0x1c0b0a09
  s_cselect_b32 s35, 0xf0e0d0c, s35
  v_mov_b32 v11, s34
  v_mov_b32 v12, s35
  v_cndmask_b32 v11, v11, v12, vcc
  v_bfe_u32 v11, v11, v7, 8
  v_lshrrev_b32 v12, 1, v11
  v_xor_b32 v12, v12, v10
  v_and_b32 v11, 1, v11
  v_lshlrev_b32 v11, 3, v11
  v_lshl_add_u32 v11, v12, 4, v11
  v_add_u32 v11, v11, v9
  v_add_u32 v120, 65536, v11
  s_mov_b32 s34, 0x15141119
  s_cselect_b32 s34, 0x16131204, s34
  s_mov_b32 s35, 0x1b1a1d
  s_cselect_b32 s35, 0x5101708, s35
  v_mov_b32 v11, s34
  v_mov_b32 v12, s35
  v_cndmask_b32 v11, v11, v12, vcc
  v_bfe_u32 v11, v11, v7, 8
  v_lshrrev_b32 v12, 1, v11
  v_xor_b32 v12, v12, v10
  v_and_b32 v11, 1, v11
  v_lshlrev_b32 v11, 3, v11
  v_lshl_add_u32 v11, v12, 4, v11
  v_add_u32 v11, v11, v9
  v_add_u32 v121, 65536, v11
  v_mov_b32 v150, 0x3f803f80
  v_mov_b32 v151, 0xc000
  v_mov_b32 v148, 0
  v_mov_b32 v149, 0
  v_mov_b32 v16, 0
  v_mov_b32 v17, 0
  v_mov_b32 v18, 0
  v_mov_b32 v19, 0
  v_mov_b32 v20, 0
  v_mov_b32 v21, 0
  v_mov_b32 v22, 0
  v_mov_b32 v23, 0
  v_mov_b32 v24, 0
  v_mov_b32 v25, 0
  v_mov_b32 v26, 0
  v_mov_b32 v27, 0
  v_mov_b32 v28, 0
  v_mov_b32 v29, 0
  v_mov_b32 v30, 0
  v_mov_b32 v31, 0
  v_mov_b32 v32, 0
  v_mov_b32 v33, 0
  v_mov_b32 v34, 0
  v_mov_b32 v35, 0
  v_mov_b32 v36, 0
  v_mov_b32 v37, 0
  v_mov_b32 v38, 0
  v_mov_b32 v39, 0
  v_mov_b32 v40, 0
  v_mov_b32 v41, 0
  v_mov_b32 v42, 0
  v_mov_b32 v43, 0
  v_mov_b32 v44, 0
  v_mov_b32 v45, 0
  v_mov_b32 v46, 0
  v_mov_b32 v47, 0
  v_mov_b32 v48, 0
  v_mov_b32 v49, 0
  v_mov_b32 v50, 0
  v_mov_b32 v51, 0
  v_mov_b32 v52, 0
  v_mov_b32 v53, 0
  v_mov_b32 v54, 0
  v_mov_b32 v55, 0
  v_mov_b32 v56, 0
  v_mov_b32 v57, 0
  v_mov_b32 v58, 0
  v_mov_b32 v59, 0
  v_mov_b32 v60, 0
  v_mov_b32 v61, 0
  v_mov_b32 v62, 0
  v_mov_b32 v63, 0
  v_mov_b32 v64, 0
  v_mov_b32 v65, 0
  v_mov_b32 v66, 0
  v_mov_b32 v67, 0
  v_mov_b32 v68, 0
  v_mov_b32 v69, 0
  v_mov_b32 v70, 0
  v_mov_b32 v71, 0
  v_mov_b32 v72, 0
  v_mov_b32 v73, 0
  v_mov_b32 v74, 0
  v_mov_b32 v75, 0
  v_mov_b32 v76, 0
  v_mov_b32 v77, 0
  v_mov_b32 v78, 0
  v_mov_b32 v79, 0
  v_mov_b32 v12, 0
  v_mov_b32 v13, 0
  v_mov_b32 v14, 0
  v_mov_b32 v15, 0
  v_lshlrev_b32 v11, 4, v1
  v_add_u32 v11, 157696, v11
  ds_write_b128 v11, v[12:15]
  v_lshrrev_b32 v11, 1, v4
  v_cmp_eq_u32 s[36:37], v11, v8
  v_lshrrev_b32 v12, 3, v7
  v_lshlrev_b32 v13, 11, v8
  v_mul_u32_u24 v14, 40, v5
  v_add_u32 v13, v13, v14
  v_lshl_add_u32 v13, v12, 3, v13
  s_mul_i32 s34, s27, 800
  s_add_u32 s34, s34, 153600
  v_add_u32 v13, s34, v13
  v_mov_b32 v14, 157696
  v_cndmask_b32 v152, v14, v13, s[36:37]
  v_add_u32 v13, 32, v13
  v_cmp_eq_u32 vcc, 0, v12
  s_nop 0
  s_and_b64 s[36:37], s[36:37], vcc
  v_cndmask_b32 v153, v14, v13, s[36:37]
  s_waitcnt lgkmcnt(0)
  s_barrier
  s_waitcnt vmcnt(0)
  v_mov_b32 v204, 0
  v_mov_b32 v205, 0
  v_mov_b32 v206, 0
  v_mov_b32 v207, 0
  v_lshlrev_b32 v208, 16, v192
  v_and_b32 v209, 0xffff0000, v192
  v_add_f32 v204, v204, v208
  v_fma_f32 v206, v208, v208, v206
  v_add_f32 v205, v205, v209
  v_fma_f32 v207, v209, v209, v207
  v_lshlrev_b32 v208, 16, v193
  v_and_b32 v209, 0xffff0000, v193
  v_add_f32 v204, v204, v208
  v_fma_f32 v206, v208, v208, v206
  v_add_f32 v205, v205, v209
  v_fma_f32 v207, v209, v209, v207
  v_lshlrev_b32 v208, 16, v194
  v_and_b32 v209, 0xffff0000, v194
  v_add_f32 v204, v204, v208
  v_fma_f32 v206, v208, v208, v206
  v_add_f32 v205, v205, v209
  v_fma_f32 v207, v209, v209, v207
  v_lshlrev_b32 v208, 16, v195
  v_and_b32 v209, 0xffff0000, v195
  v_add_f32 v204, v204, v208
  v_fma_f32 v206, v208, v208, v206
  v_add_f32 v205, v205, v209
  v_fma_f32 v207, v209, v209, v207
  v_lshlrev_b32 v208, 16, v196
  v_and_b32 v209, 0xffff0000, v196
  v_add_f32 v204, v204, v208
  v_fma_f32 v206, v208, v208, v206
  v_add_f32 v205, v205, v209
  v_fma_f32 v207, v209, v209, v207
  v_lshlrev_b32 v208, 16, v197
  v_and_b32 v209, 0xffff0000, v197
  v_add_f32 v204, v204, v208
  v_fma_f32 v206, v208, v208, v206
  v_add_f32 v205, v205, v209
  v_fma_f32 v207, v209, v209, v207
  v_lshlrev_b32 v208, 16, v198
  v_and_b32 v209, 0xffff0000, v198
  v_add_f32 v204, v204, v208
  v_fma_f32 v206, v208, v208, v206
  v_add_f32 v205, v205, v209
  v_fma_f32 v207, v209, v209, v207
  v_lshlrev_b32 v208, 16, v199
  v_and_b32 v209, 0xffff0000, v199
  v_add_f32 v204, v204, v208
  v_fma_f32 v206, v208, v208, v206
  v_add_f32 v205, v205, v209
  v_fma_f32 v207, v209, v209, v207
  v_lshlrev_b32 v208, 16, v200
  v_and_b32 v209, 0xffff0000, v200
  v_add_f32 v204, v204, v208
  v_fma_f32 v206, v208, v208, v206
  v_add_f32 v205, v205, v209
  v_fma_f32 v207, v209, v209, v207
  v_lshlrev_b32 v208, 16, v201
  v_and_b32 v209, 0xffff0000, v201
  v_add_f32 v204, v204, v208
  v_fma_f32 v206, v208, v208, v206
  v_add_f32 v205, v205, v209
  v_fma_f32 v207, v209, v209, v207
  v_lshlrev_b32 v208, 16, v202
  v_and_b32 v209, 0xffff0000, v202
  v_add_f32 v204, v204, v208
  v_fma_f32 v206, v208, v208, v206
  v_add_f32 v205, v205, v209
  v_fma_f32 v207, v209, v209, v207
  v_lshlrev_b32 v208, 16, v203
  v_and_b32 v209, 0xffff0000, v203
  v_add_f32 v204, v204, v208
  v_fma_f32 v206, v208, v208, v206
  v_add_f32 v205, v205, v209
  v_fma_f32 v207, v209, v209, v207
  v_add_f32 v204, v204, v205
  v_add_f32 v206, v206, v207
  s_nop 0
  v_add_f32_dpp v204, v204, v204 row_ror:8 row_mask:0xf bank_mask:0xf
  v_add_f32_dpp v206, v206, v206 row_ror:8 row_mask:0xf bank_mask:0xf
  s_nop 0
  v_add_f32_dpp v204, v204, v204 row_ror:4 row_mask:0xf bank_mask:0xf
  v_add_f32_dpp v206, v206, v206 row_ror:4 row_mask:0xf bank_mask:0xf
  s_nop 0
  v_add_f32_dpp v204, v204, v204 row_ror:2 row_mask:0xf bank_mask:0xf
  v_add_f32_dpp v206, v206, v206 row_ror:2 row_mask:0xf bank_mask:0xf
  s_nop 0
  v_add_f32_dpp v204, v204, v204 row_ror:1 row_mask:0xf bank_mask:0xf
  v_add_f32_dpp v206, v206, v206 row_ror:1 row_mask:0xf bank_mask:0xf
  v_mov_b32 v208, v204
  s_nop 1
  v_permlane16_swap_b32 v204, v208
  v_add_f32 v204, v204, v208
  v_mov_b32 v208, v206
  s_nop 1
  v_permlane16_swap_b32 v206, v208
  v_add_f32 v206, v206, v208
  s_mov_b32 s36, 0x3acccccd
  v_mul_f32 v204, s36, v204
  v_mul_f32 v206, s36, v206
  v_fma_f32 v206, -v204, v204, v206
  v_max_f32 v206, 0, v206
  v_add_f32 v206, 0x3727c5ac, v206
  v_rsq_f32 v205, v206
  v_sub_f32 v204, 0, v204
  v_lshrrev_b32 v208, 5, v1
  v_lshlrev_b32 v208, 3, v208
  s_mov_b32 exec_lo, 1
  s_mov_b32 exec_hi, 1
  buffer_store_dwordx2 v[204:205], v208, s[20:23], s45 offen sc1
  s_mov_b64 exec, -1
  s_cmp_eq_u32 s3, 2
  s_cbranch_scc0 Lwof_2
  s_lshl_b32 s46, s4, 1
  s_add_u32 s46, s46, s7
  s_cmp_lt_u32 s46, 20
  s_cbranch_scc0 Lwof_2
  s_mul_i32 s36, s46, 40
  s_sub_u32 s37, s46, 16
  s_mul_i32 s37, s37, 160
  s_add_u32 s37, s37, 16
  s_cmp_lt_u32 s46, 16
  s_cselect_b32 s36, s36, s37
  s_cselect_b64 s[38:39], -1, 0
  s_mul_i32 s36, s36, 1280
  s_mul_i32 s37, s24, 160
  s_add_u32 s36, s36, s37
  s_mov_b32 s16, s66
  s_mov_b32 s17, s67
  s_mov_b32 s18, 0xc8000
  s_mov_b32 s19, 0x20000
  v_add_u32 v2, 0, v1
  v_mul_u32_u24 v3, 6554, v2
  v_lshrrev_b32 v3, 16, v3
  v_mul_u32_u24 v4, 10, v3
  v_sub_u32 v4, v2, v4
  v_lshrrev_b32 v5, 4, v3
  v_mul_u32_u24 v6, 20, v5
  v_and_b32 v7, 15, v3
  v_add_u32 v6, v6, v7
  v_bfe_u32 v7, v3, 2, 1
  v_lshl_add_u32 v7, v5, 1, v7
  v_mul_u32_u24 v7, 40, v7
  v_bfe_u32 v8, v3, 3, 1
  v_mul_u32_u24 v8, 20, v8
  v_add_u32 v7, v7, v8
  v_and_b32 v8, 3, v3
  v_add_u32 v7, v7, v8
  v_cndmask_b32 v6, v7, v6, s[38:39]
  v_mul_u32_u24 v6, 1280, v6
  v_lshl_add_u32 v6, v4, 4, v6
  buffer_load_dwordx4 v[212:215], v6, s[16:19], s36 offen
  v_add_u32 v2, 64, v1
  v_mul_u32_u24 v3, 6554, v2
  v_lshrrev_b32 v3, 16, v3
  v_mul_u32_u24 v4, 10, v3
  v_sub_u32 v4, v2, v4
  v_lshrrev_b32 v5, 4, v3
  v_mul_u32_u24 v6, 20, v5
  v_and_b32 v7, 15, v3
  v_add_u32 v6, v6, v7
  v_bfe_u32 v7, v3, 2, 1
  v_lshl_add_u32 v7, v5, 1, v7
  v_mul_u32_u24 v7, 40, v7
  v_bfe_u32 v8, v3, 3, 1
  v_mul_u32_u24 v8, 20, v8
  v_add_u32 v7, v7, v8
  v_and_b32 v8, 3, v3
  v_add_u32 v7, v7, v8
  v_cndmask_b32 v6, v7, v6, s[38:39]
  v_mul_u32_u24 v6, 1280, v6
  v_lshl_add_u32 v6, v4, 4, v6
  buffer_load_dwordx4 v[216:219], v6, s[16:19], s36 offen
  v_add_u32 v2, 128, v1
  v_mul_u32_u24 v3, 6554, v2
  v_lshrrev_b32 v3, 16, v3
  v_mul_u32_u24 v4, 10, v3
  v_sub_u32 v4, v2, v4
  v_lshrrev_b32 v5, 4, v3
  v_mul_u32_u24 v6, 20, v5
  v_and_b32 v7, 15, v3
  v_add_u32 v6, v6, v7
  v_bfe_u32 v7, v3, 2, 1
  v_lshl_add_u32 v7, v5, 1, v7
  v_mul_u32_u24 v7, 40, v7
  v_bfe_u32 v8, v3, 3, 1
  v_mul_u32_u24 v8, 20, v8
  v_add_u32 v7, v7, v8
  v_and_b32 v8, 3, v3
  v_add_u32 v7, v7, v8
  v_cndmask_b32 v6, v7, v6, s[38:39]
  v_mul_u32_u24 v6, 1280, v6
  v_lshl_add_u32 v6, v4, 4, v6
  buffer_load_dwordx4 v[220:223], v6, s[16:19], s36 offen
  v_add_u32 v2, 192, v1
  v_mul_u32_u24 v3, 6554, v2
  v_lshrrev_b32 v3, 16, v3
  v_mul_u32_u24 v4, 10, v3
  v_sub_u32 v4, v2, v4
  v_lshrrev_b32 v5, 4, v3
  v_mul_u32_u24 v6, 20, v5
  v_and_b32 v7, 15, v3
  v_add_u32 v6, v6, v7
  v_bfe_u32 v7, v3, 2, 1
  v_lshl_add_u32 v7, v5, 1, v7
  v_mul_u32_u24 v7, 40, v7
  v_bfe_u32 v8, v3, 3, 1
  v_mul_u32_u24 v8, 20, v8
  v_add_u32 v7, v7, v8
  v_and_b32 v8, 3, v3
  v_add_u32 v7, v7, v8
  v_cndmask_b32 v6, v7, v6, s[38:39]
  v_mul_u32_u24 v6, 1280, v6
  v_lshl_add_u32 v6, v4, 4, v6
  buffer_load_dwordx4 v[224:227], v6, s[16:19], s36 offen
  v_add_u32 v2, 256, v1
  v_mul_u32_u24 v3, 6554, v2
  v_lshrrev_b32 v3, 16, v3
  v_mul_u32_u24 v4, 10, v3
  v_sub_u32 v4, v2, v4
  v_lshrrev_b32 v5, 4, v3
  v_mul_u32_u24 v6, 20, v5
  v_and_b32 v7, 15, v3
  v_add_u32 v6, v6, v7
  v_bfe_u32 v7, v3, 2, 1
  v_lshl_add_u32 v7, v5, 1, v7
  v_mul_u32_u24 v7, 40, v7
  v_bfe_u32 v8, v3, 3, 1
  v_mul_u32_u24 v8, 20, v8
  v_add_u32 v7, v7, v8
  v_and_b32 v8, 3, v3
  v_add_u32 v7, v7, v8
  v_cndmask_b32 v6, v7, v6, s[38:39]
  v_mul_u32_u24 v6, 1280, v6
  v_lshl_add_u32 v6, v4, 4, v6
  buffer_load_dwordx4 v[228:231], v6, s[16:19], s36 offen
Lwof_2:
  s_cmp_eq_u32 s3, 3
  s_cbranch_scc0 Linit_3
  s_cmp_eq_u32 s2, 0
  s_cbranch_scc0 Linit_3
  s_memrealtime s[36:37]
  s_waitcnt lgkmcnt(0)
  s_or_b32 s36, s36, 1
  v_mov_b32 v2, s36
  v_mov_b32 v3, s37
  v_mov_b32 v4, 0
  s_mov_b64 exec, 1
  buffer_store_dwordx2 v[2:3], v4, s[28:31], 0 offen sc1
  s_mov_b64 exec, -1
Linit_3:
  s_mov_b32 s44, 0
  s_barrier
  ds_read_b128 v[80:83], v112
  ds_read_b64_tr_b16 v[88:89], v120 offset:0
  ds_read_b64_tr_b16 v[90:91], v120 offset:1024
  ds_read_b64_tr_b16 v[92:93], v121 offset:0
  ds_read_b64_tr_b16 v[94:95], v121 offset:1024
  ds_read_b128 v[84:87], v116
  s_mov_b32 s32, 0
  s_mov_b32 s33, 0
Lp1_4:
  s_waitcnt lgkmcnt(3)
  v_mfma_f32_32x32x16_bf16 v[16:31], v[88:91], v[80:83], v[16:31]
  ds_read_b128 v[96:99], v113
  ds_read_b64_tr_b16 v[104:105], v120 offset:4096
  s_waitcnt lgkmcnt(3)
  v_mfma_f32_32x32x16_bf16 v[32:47], v[92:95], v[80:83], v[32:47]
  ds_read_b64_tr_b16 v[106:107], v120 offset:5120
  ds_read_b64_tr_b16 v[108:109], v121 offset:4096
  s_waitcnt lgkmcnt(4)
  v_mfma_f32_32x32x16_bf16 v[48:63], v[88:91], v[84:87], v[48:63]
  ds_read_b64_tr_b16 v[110:111], v121 offset:5120
  ds_read_b128 v[100:103], v117
  v_mfma_f32_32x32x16_bf16 v[64:79], v[92:95], v[84:87], v[64:79]
  v_dot2c_f32_bf16 v148, v88, v150
  v_dot2c_f32_bf16 v149, v92, v150
  v_dot2c_f32_bf16 v148, v89, v150
  v_dot2c_f32_bf16 v149, v93, v150
  v_dot2c_f32_bf16 v148, v90, v150
  v_dot2c_f32_bf16 v149, v94, v150
  v_dot2c_f32_bf16 v148, v91, v150
  v_dot2c_f32_bf16 v149, v95, v150
  s_waitcnt lgkmcnt(3)
  v_mfma_f32_32x32x16_bf16 v[16:31], v[104:107], v[96:99], v[16:31]
  ds_read_b128 v[80:83], v114
  ds_read_b64_tr_b16 v[88:89], v120 offset:8192
  s_waitcnt lgkmcnt(3)
  v_mfma_f32_32x32x16_bf16 v[32:47], v[108:111], v[96:99], v[32:47]
  ds_read_b64_tr_b16 v[90:91], v120 offset:9216
  ds_read_b64_tr_b16 v[92:93], v121 offset:8192
  s_waitcnt lgkmcnt(4)
  v_mfma_f32_32x32x16_bf16 v[48:63], v[104:107], v[100:103], v[48:63]
  ds_read_b64_tr_b16 v[94:95], v121 offset:9216
  ds_read_b128 v[84:87], v118
  v_mfma_f32_32x32x16_bf16 v[64:79], v[108:111], v[100:103], v[64:79]
  v_dot2c_f32_bf16 v148, v104, v150
  v_dot2c_f32_bf16 v149, v108, v150
  v_dot2c_f32_bf16 v148, v105, v150
  v_dot2c_f32_bf16 v149, v109, v150
  v_dot2c_f32_bf16 v148, v106, v150
  v_dot2c_f32_bf16 v149, v110, v150
  v_dot2c_f32_bf16 v148, v107, v150
  v_dot2c_f32_bf16 v149, v111, v150
  s_waitcnt lgkmcnt(3)
  v_mfma_f32_32x32x16_bf16 v[16:31], v[88:91], v[80:83], v[16:31]
  ds_read_b128 v[96:99], v115
  ds_read_b64_tr_b16 v[104:105], v120 offset:12288
  s_waitcnt lgkmcnt(3)
  v_mfma_f32_32x32x16_bf16 v[32:47], v[92:95], v[80:83], v[32:47]
  ds_read_b64_tr_b16 v[106:107], v120 offset:13312
  ds_read_b64_tr_b16 v[108:109], v121 offset:12288
  s_waitcnt lgkmcnt(4)
  v_mfma_f32_32x32x16_bf16 v[48:63], v[88:91], v[84:87], v[48:63]
  ds_read_b64_tr_b16 v[110:111], v121 offset:13312
  ds_read_b128 v[100:103], v119
  v_mfma_f32_32x32x16_bf16 v[64:79], v[92:95], v[84:87], v[64:79]
  v_dot2c_f32_bf16 v148, v88, v150
  v_dot2c_f32_bf16 v149, v92, v150
  v_dot2c_f32_bf16 v148, v89, v150
  v_dot2c_f32_bf16 v149, v93, v150
  v_dot2c_f32_bf16 v148, v90, v150
  v_dot2c_f32_bf16 v149, v94, v150
  v_dot2c_f32_bf16 v148, v91, v150
  v_dot2c_f32_bf16 v149, v95, v150
  s_waitcnt lgkmcnt(3)
  v_mfma_f32_32x32x16_bf16 v[16:31], v[104:107], v[96:99], v[16:31]
  s_waitcnt lgkmcnt(1)
  v_mfma_f32_32x32x16_bf16 v[32:47], v[108:111], v[96:99], v[32:47]
  s_add_u32 s33, s33, 0x4000
  s_and_b32 s33, s33, 0xc000
  s_waitcnt lgkmcnt(0)
  v_mfma_f32_32x32x16_bf16 v[48:63], v[104:107], v[100:103], v[48:63]
  s_barrier
  v_bfi_b32 v112, v151, s33, v112
  v_bfi_b32 v120, v151, s33, v120
  v_bfi_b32 v121, v151, s33, v121
  v_bfi_b32 v116, v151, s33, v116
  ds_read_b128 v[80:83], v112
  ds_read_b64_tr_b16 v[88:89], v120 offset:0
  ds_read_b64_tr_b16 v[90:91], v120 offset:1024
  v_mfma_f32_32x32x16_bf16 v[64:79], v[108:111], v[100:103], v[64:79]
  ds_read_b64_tr_b16 v[92:93], v121 offset:0
  ds_read_b64_tr_b16 v[94:95], v121 offset:1024
  ds_read_b128 v[84:87], v116
  v_bfi_b32 v113, v151, s33, v113
  v_bfi_b32 v114, v151, s33, v114
  v_bfi_b32 v115, v151, s33, v115
  v_bfi_b32 v117, v151, s33, v117
  v_bfi_b32 v118, v151, s33, v118
  v_bfi_b32 v119, v151, s33, v119
  v_dot2c_f32_bf16 v148, v104, v150
  v_dot2c_f32_bf16 v149, v108, v150
  v_dot2c_f32_bf16 v148, v105, v150
  v_dot2c_f32_bf16 v149, v109, v150
  v_dot2c_f32_bf16 v148, v106, v150
  v_dot2c_f32_bf16 v149, v110, v150
  v_dot2c_f32_bf16 v148, v107, v150
  v_dot2c_f32_bf16 v149, v111, v150
  s_cmp_eq_u32 s32, s44
  s_cbranch_scc1 Lev_5
Levb_6:
  s_add_u32 s32, s32, 1
  s_cmp_lt_u32 s32, 10
  s_cbranch_scc1 Lp1_4
  s_branch Laft_7
Lev_5:
  s_cmp_eq_u32 s44, 2
  s_cbranch_scc1 Le2_8
  s_cmp_eq_u32 s44, 5
  s_cbranch_scc1 Le6_9
  s_cmp_eq_u32 s44, 7
  s_cbranch_scc1 Le8_10
  s_cmp_eq_u32 s44, 3
  s_cbranch_scc1 Le3_12
  s_waitcnt vmcnt(0)
  s_mov_b32 s44, 99
  s_cmp_eq_u32 s3, 2
  s_cbranch_scc0 Lw2_13
  s_lshl_b32 s46, s4, 1
  s_add_u32 s46, s46, s7
  s_cmp_lt_u32 s46, 20
  s_cbranch_scc0 Lwoft_14
  v_lshlrev_b32 v2, 4, v1
  v_add_u32 v3, 131072, v2
  ds_write_b128 v3, v[212:215] offset:0
  ds_write_b128 v3, v[216:219] offset:1024
  ds_write_b128 v3, v[220:223] offset:2048
  ds_write_b128 v3, v[224:227] offset:3072
  ds_write_b128 v3, v[228:231] offset:4096
  v_lshrrev_b32 v4, 4, v1
  v_bfe_u32 v5, v1, 2, 2
  v_and_b32 v6, 3, v1
  v_lshrrev_b32 v8, 1, v4
  v_lshlrev_b32 v8, 4, v8
  v_and_b32 v9, 1, v4
  v_lshl_add_u32 v8, v9, 2, v8
  v_add_u32 v8, v8, v5
  v_mul_u32_u24 v8, 160, v8
  v_lshl_add_u32 v8, v6, 3, v8
  v_add_u32 v8, 131072, v8
  s_waitcnt lgkmcnt(0)
  ds_read_b64_tr_b16 v[212:213], v8 offset:0
  ds_read_b64_tr_b16 v[214:215], v8 offset:1280
  ds_read_b64_tr_b16 v[216:217], v8 offset:32
  ds_read_b64_tr_b16 v[218:219], v8 offset:1312
  ds_read_b64_tr_b16 v[220:221], v8 offset:64
  ds_read_b64_tr_b16 v[222:223], v8 offset:1344
  ds_read_b64_tr_b16 v[224:225], v8 offset:96
  ds_read_b64_tr_b16 v[226:227], v8 offset:1376
  ds_read_b64_tr_b16 v[228:229], v8 offset:128
  ds_read_b64_tr_b16 v[230:231], v8 offset:1408
  s_mul_i32 s36, s24, 20
  s_add_u32 s36, s36, s46
  s_mul_i32 s36, s36, 5120
  s_add_u32 s36, s36, 32505856
  s_waitcnt lgkmcnt(0)
  s_add_u32 s37, s36, 0
  buffer_store_dwordx4 v[212:215], v2, s[20:23], s37 offen sc1
  s_add_u32 s37, s36, 1024
  buffer_store_dwordx4 v[216:219], v2, s[20:23], s37 offen sc1
  s_add_u32 s37, s36, 2048
  buffer_store_dwordx4 v[220:223], v2, s[20:23], s37 offen sc1
  s_add_u32 s37, s36, 3072
  buffer_store_dwordx4 v[224:227], v2, s[20:23], s37 offen sc1
  s_add_u32 s37, s36, 4096
  buffer_store_dwordx4 v[228:231], v2, s[20:23], s37 offen sc1
Lwoft_14:
  s_mov_b32 s44, 3
  s_branch Levb_6
Le3_12:
  s_waitcnt vmcnt(0)
  v_mov_b32 v6, 160784
  ds_read_b64 v[6:7], v6
  s_waitcnt lgkmcnt(0)
  v_readfirstlane_b32 s56, v6
  v_readfirstlane_b32 s57, v7
  s_lshl_b32 s38, s5, 11
  s_lshl_b32 s39, s4, 7
  s_add_u32 s38, s38, s39
  s_add_u32 s38, s38, 22216704
  v_mov_b32 v6, s56
  v_mov_b32 v7, s57
  v_mov_b32 v5, 0
  s_mov_b64 exec, 1
  buffer_store_dwordx2 v[6:7], v5, s[20:23], s38 offen sc1
  s_mov_b64 exec, -1
  s_mov_b32 s44, 99
  s_branch Levb_6
Lw2_13:
  s_cmp_eq_u32 s3, 1
  s_cbranch_scc0 Levb_6
  v_mov_b32 v5, 0
  buffer_load_dwordx2 v[6:7], v5, s[28:31], 0 offen sc1
  s_mov_b32 s44, 2
  s_branch Levb_6
Le2_8:
  s_waitcnt vmcnt(0)
  v_or_b32 v8, v6, v7
  s_nop 0
  v_readfirstlane_b32 s41, v8
  s_nop 0
  s_cmp_lg_u32 s41, 0
  s_cbranch_scc1 Lok_15
  s_mov_b32 s40, 0
Lpoll_16:
  s_add_u32 s40, s40, 1
  s_cmp_gt_u32 s40, 1048576
  s_cbranch_scc1 Lpollx_17
  buffer_load_dwordx2 v[6:7], v5, s[28:31], 0 offen sc1
  s_waitcnt vmcnt(0)
  v_or_b32 v8, v6, v7
  s_nop 0
  v_readfirstlane_b32 s41, v8
  s_nop 0
  s_cmp_lg_u32 s41, 0
  s_cbranch_scc0 Lpoll_16
Lpollx_17:
Lok_15:
  v_readfirstlane_b32 s56, v6
  v_readfirstlane_b32 s57, v7
  v_mov_b32 v8, 160784
  ds_write_b64 v8, v[6:7]
  s_getreg_b32 s36, hwreg(HW_REG_XCC_ID, 0, 4)
  s_lshl_b32 s37, s57, 4
  s_or_b32 s37, s37, s36
  v_mov_b32 v7, s37
  s_lshl_b32 s38, s4, 11
  s_lshl_b32 s39, s5, 7
  s_add_u32 s38, s38, s39
  s_add_u32 s38, s38, 22151168
  s_mov_b64 exec, 1
  buffer_store_dwordx2 v[6:7], v5, s[20:23], s38 offen sc1
  s_mov_b64 exec, -1
  s_mov_b32 s44, 5
  s_branch Levb_6
Le6_9:
  s_lshl_b32 s38, s4, 11
  s_add_u32 s38, s38, 22151168
  v_and_b32 v5, 15, v1
  v_lshlrev_b32 v5, 7, v5
  buffer_load_dwordx2 v[6:7], v5, s[20:23], s38 offen sc1
  s_mov_b32 s44, 7
  s_branch Levb_6
Le8_10:
  s_lshl_b32 s38, s4, 11
  s_add_u32 s38, s38, 22151168
  s_waitcnt vmcnt(0)
  s_lshl_b32 s37, s57, 4
  s_lshr_b32 s37, s37, 4
  v_lshrrev_b32 v8, 4, v7
  v_cmp_eq_u32 vcc, s56, v6
  v_cmp_eq_u32 s[42:43], s37, v8
  s_nop 0
  s_and_b64 vcc, vcc, s[42:43]
  s_cmp_eq_u64 vcc, -1
  s_cbranch_scc1 Lok_18
  s_mov_b32 s40, 0
Lpoll_19:
  s_add_u32 s40, s40, 1
  s_cmp_gt_u32 s40, 1048576
  s_cbranch_scc1 Lpollx_20
  buffer_load_dwordx2 v[6:7], v5, s[20:23], s38 offen sc1
  s_waitcnt vmcnt(0)
  s_lshl_b32 s37, s57, 4
  s_lshr_b32 s37, s37, 4
  v_lshrrev_b32 v8, 4, v7
  v_cmp_eq_u32 vcc, s56, v6
  v_cmp_eq_u32 s[42:43], s37, v8
  s_nop 0
  s_and_b64 vcc, vcc, s[42:43]
  s_cmp_eq_u64 vcc, -1
  s_cbranch_scc0 Lpoll_19
Lpollx_20:
Lok_18:
  v_readfirstlane_b32 s41, v7
  s_nop 1
  v_cmp_eq_u32 vcc, s41, v7
  s_nop 0
  s_cmp_eq_u64 vcc, -1
  s_cselect_b32 s41, 1, 0
  v_mov_b32 v6, s41
  v_mov_b32 v7, 160768
  ds_write_b32 v7, v6
  s_lshl_b32 s38, s4, 10
  s_add_u32 s38, s38, 22282240
  v_lshlrev_b32 v5, 4, v1
  buffer_load_dwordx4 v[4:7], v5, s[20:23], s38 offen sc1
  s_mov_b32 s44, 99
  s_branch Levb_6
Laft_7:
  ds_read_b64_tr_b16 v[124:125], v152 offset:0
  ds_read_b64_tr_b16 v[126:127], v152 offset:160
  ds_read_b64_tr_b16 v[128:129], v152 offset:320
  ds_read_b64_tr_b16 v[130:131], v152 offset:480
  ds_read_b64_tr_b16 v[132:133], v152 offset:640
  v_mov_b32 v134, 0
  v_mov_b32 v135, 0
  ds_read_b64_tr_b16 v[136:137], v153 offset:0
  ds_read_b64_tr_b16 v[138:139], v153 offset:160
  ds_read_b64_tr_b16 v[140:141], v153 offset:320
  ds_read_b64_tr_b16 v[142:143], v153 offset:480
  ds_read_b64_tr_b16 v[144:145], v153 offset:640
  v_mov_b32 v146, 0
  v_mov_b32 v147, 0
  s_cmp_eq_u32 s3, 1
  s_cbranch_scc0 Lef_21
  s_waitcnt vmcnt(0)
  v_lshlrev_b32 v8, 4, v1
  v_add_u32 v8, 158720, v8
  ds_write_b128 v8, v[4:7]
Lef_21:
  s_waitcnt lgkmcnt(0)
  v_mov_b32 v2, v148
  s_nop 1
  v_permlane32_swap_b32 v148, v2
  v_add_f32 v148, v148, v2
  v_mov_b32 v2, v149
  s_nop 1
  v_permlane32_swap_b32 v149, v2
  v_add_f32 v149, v149, v2
  v_and_b32 v2, 31, v1
  v_lshrrev_b32 v3, 5, v1
  s_lshl_b32 s35, s3, 8
  s_add_u32 s35, s35, 159744
  v_lshl_add_u32 v5, v2, 2, s35
  ds_write_b32 v5, v148
  ds_write_b32 v5, v149 offset:128
  s_waitcnt lgkmcnt(0)
  s_barrier
  s_lshl_b32 s34, s26, 9
  s_add_u32 s34, s34, 158720
  v_lshl_add_u32 v4, v2, 3, s34
  s_lshl_b32 s34, s27, 8
  v_add_u32 v6, s34, v4
  s_sub_u32 s34, 256, s34
  v_add_u32 v7, s34, v4
  ds_read_b64 v[8:9], v6
  ds_read_b64 v[10:11], v7
  v_lshl_add_u32 v5, v3, 4, s35
  ds_read_b128 v[192:195], v5 offset:0
  ds_read_b128 v[196:199], v5 offset:32
  ds_read_b128 v[200:203], v5 offset:64
  ds_read_b128 v[204:207], v5 offset:96
  ds_read_b128 v[208:211], v5 offset:128
  ds_read_b128 v[212:215], v5 offset:160
  ds_read_b128 v[216:219], v5 offset:192
  ds_read_b128 v[220:223], v5 offset:224
  v_mov_b32 v6, 160784
  ds_read_b64 v[6:7], v6
  s_waitcnt lgkmcnt(0)
  v_readfirstlane_b32 s56, v6
  v_readfirstlane_b32 s57, v7
  v_mov_b32 v152, v8
  v_mov_b32 v156, v9
  v_mov_b32 v154, v10
  v_mov_b32 v158, v11
  v_pk_fma_f32 v[16:17], v[192:193], v[152:153], v[16:17] op_sel_hi:[1,0,1]
  v_pk_fma_f32 v[18:19], v[194:195], v[152:153], v[18:19] op_sel_hi:[1,0,1]
  v_pk_fma_f32 v[20:21], v[196:197], v[152:153], v[20:21] op_sel_hi:[1,0,1]
  v_pk_fma_f32 v[22:23], v[198:199], v[152:153], v[22:23] op_sel_hi:[1,0,1]
  v_pk_fma_f32 v[24:25], v[200:201], v[152:153], v[24:25] op_sel_hi:[1,0,1]
  v_pk_fma_f32 v[26:27], v[202:203], v[152:153], v[26:27] op_sel_hi:[1,0,1]
  v_pk_fma_f32 v[28:29], v[204:205], v[152:153], v[28:29] op_sel_hi:[1,0,1]
  v_pk_fma_f32 v[30:31], v[206:207], v[152:153], v[30:31] op_sel_hi:[1,0,1]
  v_pk_mul_f32 v[16:17], v[16:17], v[156:157] op_sel_hi:[1,0]
  v_pk_mul_f32 v[18:19], v[18:19], v[156:157] op_sel_hi:[1,0]
  v_pk_mul_f32 v[20:21], v[20:21], v[156:157] op_sel_hi:[1,0]
  v_pk_mul_f32 v[22:23], v[22:23], v[156:157] op_sel_hi:[1,0]
  v_pk_mul_f32 v[24:25], v[24:25], v[156:157] op_sel_hi:[1,0]
  v_pk_mul_f32 v[26:27], v[26:27], v[156:157] op_sel_hi:[1,0]
  v_pk_mul_f32 v[28:29], v[28:29], v[156:157] op_sel_hi:[1,0]
  v_pk_mul_f32 v[30:31], v[30:31], v[156:157] op_sel_hi:[1,0]
  v_cvt_pk_bf16_f32 v160, v16, v17
  v_cvt_pk_bf16_f32 v161, v18, v19
  v_cvt_pk_bf16_f32 v162, v20, v21
  v_cvt_pk_bf16_f32 v163, v22, v23
  v_cvt_pk_bf16_f32 v164, v24, v25
  v_cvt_pk_bf16_f32 v165, v26, v27
  v_cvt_pk_bf16_f32 v166, v28, v29
  v_cvt_pk_bf16_f32 v167, v30, v31
  v_pk_fma_f32 v[32:33], v[208:209], v[152:153], v[32:33] op_sel_hi:[1,0,1]
  v_pk_fma_f32 v[34:35], v[210:211], v[152:153], v[34:35] op_sel_hi:[1,0,1]
  v_pk_fma_f32 v[36:37], v[212:213], v[152:153], v[36:37] op_sel_hi:[1,0,1]
  v_pk_fma_f32 v[38:39], v[214:215], v[152:153], v[38:39] op_sel_hi:[1,0,1]
  v_pk_fma_f32 v[40:41], v[216:217], v[152:153], v[40:41] op_sel_hi:[1,0,1]
  v_pk_fma_f32 v[42:43], v[218:219], v[152:153], v[42:43] op_sel_hi:[1,0,1]
  v_pk_fma_f32 v[44:45], v[220:221], v[152:153], v[44:45] op_sel_hi:[1,0,1]
  v_pk_fma_f32 v[46:47], v[222:223], v[152:153], v[46:47] op_sel_hi:[1,0,1]
  v_pk_mul_f32 v[32:33], v[32:33], v[156:157] op_sel_hi:[1,0]
  v_pk_mul_f32 v[34:35], v[34:35], v[156:157] op_sel_hi:[1,0]
  v_pk_mul_f32 v[36:37], v[36:37], v[156:157] op_sel_hi:[1,0]
  v_pk_mul_f32 v[38:39], v[38:39], v[156:157] op_sel_hi:[1,0]
  v_pk_mul_f32 v[40:41], v[40:41], v[156:157] op_sel_hi:[1,0]
  v_pk_mul_f32 v[42:43], v[42:43], v[156:157] op_sel_hi:[1,0]
  v_pk_mul_f32 v[44:45], v[44:45], v[156:157] op_sel_hi:[1,0]
  v_pk_mul_f32 v[46:47], v[46:47], v[156:157] op_sel_hi:[1,0]
  v_cvt_pk_bf16_f32 v168, v32, v33
  v_cvt_pk_bf16_f32 v169, v34, v35
  v_cvt_pk_bf16_f32 v170, v36, v37
  v_cvt_pk_bf16_f32 v171, v38, v39
  v_cvt_pk_bf16_f32 v172, v40, v41
  v_cvt_pk_bf16_f32 v173, v42, v43
  v_cvt_pk_bf16_f32 v174, v44, v45
  v_cvt_pk_bf16_f32 v175, v46, v47
  v_pk_fma_f32 v[48:49], v[192:193], v[154:155], v[48:49] op_sel_hi:[1,0,1]
  v_pk_fma_f32 v[50:51], v[194:195], v[154:155], v[50:51] op_sel_hi:[1,0,1]
  v_pk_fma_f32 v[52:53], v[196:197], v[154:155], v[52:53] op_sel_hi:[1,0,1]
  v_pk_fma_f32 v[54:55], v[198:199], v[154:155], v[54:55] op_sel_hi:[1,0,1]
  v_pk_fma_f32 v[56:57], v[200:201], v[154:155], v[56:57] op_sel_hi:[1,0,1]
  v_pk_fma_f32 v[58:59], v[202:203], v[154:155], v[58:59] op_sel_hi:[1,0,1]
  v_pk_fma_f32 v[60:61], v[204:205], v[154:155], v[60:61] op_sel_hi:[1,0,1]
  v_pk_fma_f32 v[62:63], v[206:207], v[154:155], v[62:63] op_sel_hi:[1,0,1]
  v_pk_mul_f32 v[48:49], v[48:49], v[158:159] op_sel_hi:[1,0]
  v_pk_mul_f32 v[50:51], v[50:51], v[158:159] op_sel_hi:[1,0]
  v_pk_mul_f32 v[52:53], v[52:53], v[158:159] op_sel_hi:[1,0]
  v_pk_mul_f32 v[54:55], v[54:55], v[158:159] op_sel_hi:[1,0]
  v_pk_mul_f32 v[56:57], v[56:57], v[158:159] op_sel_hi:[1,0]
  v_pk_mul_f32 v[58:59], v[58:59], v[158:159] op_sel_hi:[1,0]
  v_pk_mul_f32 v[60:61], v[60:61], v[158:159] op_sel_hi:[1,0]
  v_pk_mul_f32 v[62:63], v[62:63], v[158:159] op_sel_hi:[1,0]
  v_cvt_pk_bf16_f32 v176, v48, v49
  v_cvt_pk_bf16_f32 v177, v50, v51
  v_cvt_pk_bf16_f32 v178, v52, v53
  v_cvt_pk_bf16_f32 v179, v54, v55
  v_cvt_pk_bf16_f32 v180, v56, v57
  v_cvt_pk_bf16_f32 v181, v58, v59
  v_cvt_pk_bf16_f32 v182, v60, v61
  v_cvt_pk_bf16_f32 v183, v62, v63
  v_pk_fma_f32 v[64:65], v[208:209], v[154:155], v[64:65] op_sel_hi:[1,0,1]
  v_pk_fma_f32 v[66:67], v[210:211], v[154:155], v[66:67] op_sel_hi:[1,0,1]
  v_pk_fma_f32 v[68:69], v[212:213], v[154:155], v[68:69] op_sel_hi:[1,0,1]
  v_pk_fma_f32 v[70:71], v[214:215], v[154:155], v[70:71] op_sel_hi:[1,0,1]
  v_pk_fma_f32 v[72:73], v[216:217], v[154:155], v[72:73] op_sel_hi:[1,0,1]
  v_pk_fma_f32 v[74:75], v[218:219], v[154:155], v[74:75] op_sel_hi:[1,0,1]
  v_pk_fma_f32 v[76:77], v[220:221], v[154:155], v[76:77] op_sel_hi:[1,0,1]
  v_pk_fma_f32 v[78:79], v[222:223], v[154:155], v[78:79] op_sel_hi:[1,0,1]
  v_pk_mul_f32 v[64:65], v[64:65], v[158:159] op_sel_hi:[1,0]
  v_pk_mul_f32 v[66:67], v[66:67], v[158:159] op_sel_hi:[1,0]
  v_pk_mul_f32 v[68:69], v[68:69], v[158:159] op_sel_hi:[1,0]
  v_pk_mul_f32 v[70:71], v[70:71], v[158:159] op_sel_hi:[1,0]
  v_pk_mul_f32 v[72:73], v[72:73], v[158:159] op_sel_hi:[1,0]
  v_pk_mul_f32 v[74:75], v[74:75], v[158:159] op_sel_hi:[1,0]
  v_pk_mul_f32 v[76:77], v[76:77], v[158:159] op_sel_hi:[1,0]
  v_pk_mul_f32 v[78:79], v[78:79], v[158:159] op_sel_hi:[1,0]
  v_cvt_pk_bf16_f32 v184, v64, v65
  v_cvt_pk_bf16_f32 v185, v66, v67
  v_cvt_pk_bf16_f32 v186, v68, v69
  v_cvt_pk_bf16_f32 v187, v70, v71
  v_cvt_pk_bf16_f32 v188, v72, v73
  v_cvt_pk_bf16_f32 v189, v74, v75
  v_cvt_pk_bf16_f32 v190, v76, v77
  v_cvt_pk_bf16_f32 v191, v78, v79
  v_mfma_f32_32x32x16_bf16 v[16:31], v[124:127], v[160:163], 0
  v_mfma_f32_32x32x16_bf16 v[16:31], v[128:131], v[164:167], v[16:31]
  v_mfma_f32_32x32x16_bf16 v[16:31], v[132:135], v[168:171], v[16:31]
  v_mfma_f32_32x32x16_bf16 v[32:47], v[136:139], v[160:163], 0
  v_mfma_f32_32x32x16_bf16 v[32:47], v[140:143], v[164:167], v[32:47]
  v_mfma_f32_32x32x16_bf16 v[32:47], v[144:147], v[168:171], v[32:47]
  v_mfma_f32_32x32x16_bf16 v[48:63], v[124:127], v[176:179], 0
  v_mfma_f32_32x32x16_bf16 v[48:63], v[128:131], v[180:183], v[48:63]
  v_mfma_f32_32x32x16_bf16 v[48:63], v[132:135], v[184:187], v[48:63]
  v_mfma_f32_32x32x16_bf16 v[64:79], v[136:139], v[176:179], 0
  v_mfma_f32_32x32x16_bf16 v[64:79], v[140:143], v[180:183], v[64:79]
  v_mfma_f32_32x32x16_bf16 v[64:79], v[144:147], v[184:187], v[64:79]
  s_nop 8
  v_permlane32_swap_b32 v16, v48
  v_permlane32_swap_b32 v17, v49
  v_permlane32_swap_b32 v18, v50
  v_permlane32_swap_b32 v19, v51
  v_permlane32_swap_b32 v20, v52
  v_permlane32_swap_b32 v21, v53
  v_permlane32_swap_b32 v22, v54
  v_permlane32_swap_b32 v23, v55
  v_permlane32_swap_b32 v24, v56
  v_permlane32_swap_b32 v25, v57
  v_permlane32_swap_b32 v26, v58
  v_permlane32_swap_b32 v27, v59
  v_permlane32_swap_b32 v28, v60
  v_permlane32_swap_b32 v29, v61
  v_permlane32_swap_b32 v30, v62
  v_permlane32_swap_b32 v31, v63
  v_permlane32_swap_b32 v32, v64
  v_permlane32_swap_b32 v33, v65
  v_permlane32_swap_b32 v34, v66
  v_permlane32_swap_b32 v35, v67
  s_mul_i32 s34, s27, 24576
  s_lshl_b32 s35, s26, 6
  v_add_u32 v4, s35, v2
  v_mul_u32_u24 v4, 192, v4
  v_add_u32 v4, s34, v4
  s_mul_i32 s35, s27, 6144
  v_add_u32 v5, s35, v4
  s_sub_u32 s35, 6144, s35
  v_add_u32 v6, s35, v4
  v_cmp_eq_u32 vcc, 1, v3
  s_nop 1
  v_cndmask_b32 v14, v5, v6, vcc
  v_bfe_u32 v7, v2, 1, 3
  s_mov_b32 s38, 0x3fb8aa3b
  s_mov_b32 s39, 0x3fb8aa3b
  v_max3_f32 v192, v48, v49, v50
  v_max3_f32 v193, v51, v52, v53
  v_max3_f32 v194, v54, v55, v56
  v_max3_f32 v195, v57, v58, v59
  v_max3_f32 v196, v60, v61, v62
  v_max3_f32 v197, v63, v64, v65
  v_max3_f32 v198, v66, v67, v192
  v_max3_f32 v199, v193, v194, v195
  v_max3_f32 v200, v196, v197, v198
  v_max_f32 v10, v199, v200
  v_min3_f32 v202, v48, v49, v50
  v_min3_f32 v203, v51, v52, v53
  v_min3_f32 v204, v54, v55, v56
  v_min3_f32 v205, v57, v58, v59
  v_min3_f32 v206, v60, v61, v62
  v_min3_f32 v207, v63, v64, v65
  v_min3_f32 v208, v66, v67, v202
  v_min3_f32 v209, v203, v204, v205
  v_min3_f32 v210, v206, v207, v208
  v_min_f32 v12, v209, v210
  v_mul_f32 v10, 0xbfb8aa3b, v10
  v_mul_f32 v12, 0x3fb8aa3b, v12
  v_pk_fma_f32 v[192:193], v[48:49], s[38:39], v[10:11] op_sel_hi:[1,1,0]
  v_pk_fma_f32 v[212:213], v[48:49], s[38:39], v[12:13] op_sel_hi:[1,1,0] neg_lo:[1,0,0] neg_hi:[1,0,0]
  v_pk_fma_f32 v[194:195], v[50:51], s[38:39], v[10:11] op_sel_hi:[1,1,0]
  v_pk_fma_f32 v[214:215], v[50:51], s[38:39], v[12:13] op_sel_hi:[1,1,0] neg_lo:[1,0,0] neg_hi:[1,0,0]
  v_pk_fma_f32 v[196:197], v[52:53], s[38:39], v[10:11] op_sel_hi:[1,1,0]
  v_pk_fma_f32 v[216:217], v[52:53], s[38:39], v[12:13] op_sel_hi:[1,1,0] neg_lo:[1,0,0] neg_hi:[1,0,0]
  v_pk_fma_f32 v[198:199], v[54:55], s[38:39], v[10:11] op_sel_hi:[1,1,0]
  v_pk_fma_f32 v[218:219], v[54:55], s[38:39], v[12:13] op_sel_hi:[1,1,0] neg_lo:[1,0,0] neg_hi:[1,0,0]
  v_pk_fma_f32 v[200:201], v[56:57], s[38:39], v[10:11] op_sel_hi:[1,1,0]
  v_pk_fma_f32 v[220:221], v[56:57], s[38:39], v[12:13] op_sel_hi:[1,1,0] neg_lo:[1,0,0] neg_hi:[1,0,0]
  v_pk_fma_f32 v[202:203], v[58:59], s[38:39], v[10:11] op_sel_hi:[1,1,0]
  v_pk_fma_f32 v[222:223], v[58:59], s[38:39], v[12:13] op_sel_hi:[1,1,0] neg_lo:[1,0,0] neg_hi:[1,0,0]
  v_pk_fma_f32 v[204:205], v[60:61], s[38:39], v[10:11] op_sel_hi:[1,1,0]
  v_pk_fma_f32 v[224:225], v[60:61], s[38:39], v[12:13] op_sel_hi:[1,1,0] neg_lo:[1,0,0] neg_hi:[1,0,0]
  v_pk_fma_f32 v[206:207], v[62:63], s[38:39], v[10:11] op_sel_hi:[1,1,0]
  v_pk_fma_f32 v[226:227], v[62:63], s[38:39], v[12:13] op_sel_hi:[1,1,0] neg_lo:[1,0,0] neg_hi:[1,0,0]
  v_pk_fma_f32 v[208:209], v[64:65], s[38:39], v[10:11] op_sel_hi:[1,1,0]
  v_pk_fma_f32 v[228:229], v[64:65], s[38:39], v[12:13] op_sel_hi:[1,1,0] neg_lo:[1,0,0] neg_hi:[1,0,0]
  v_pk_fma_f32 v[210:211], v[66:67], s[38:39], v[10:11] op_sel_hi:[1,1,0]
  v_pk_fma_f32 v[230:231], v[66:67], s[38:39], v[12:13] op_sel_hi:[1,1,0] neg_lo:[1,0,0] neg_hi:[1,0,0]
  v_exp_f32 v192, v192
  v_exp_f32 v193, v193
  v_exp_f32 v194, v194
  v_exp_f32 v195, v195
  v_exp_f32 v196, v196
  v_exp_f32 v197, v197
  v_exp_f32 v198, v198
  v_exp_f32 v199, v199
  v_exp_f32 v200, v200
  v_exp_f32 v201, v201
  v_exp_f32 v202, v202
  v_exp_f32 v203, v203
  v_exp_f32 v204, v204
  v_exp_f32 v205, v205
  v_exp_f32 v206, v206
  v_exp_f32 v207, v207
  v_exp_f32 v208, v208
  v_exp_f32 v209, v209
  v_exp_f32 v210, v210
  v_exp_f32 v211, v211
  v_exp_f32 v212, v212
  v_exp_f32 v213, v213
  v_exp_f32 v214, v214
  v_exp_f32 v215, v215
  v_exp_f32 v216, v216
  v_exp_f32 v217, v217
  v_exp_f32 v218, v218
  v_exp_f32 v219, v219
  v_exp_f32 v220, v220
  v_exp_f32 v221, v221
  v_exp_f32 v222, v222
  v_exp_f32 v223, v223
  v_exp_f32 v224, v224
  v_exp_f32 v225, v225
  v_exp_f32 v226, v226
  v_exp_f32 v227, v227
  v_exp_f32 v228, v228
  v_exp_f32 v229, v229
  v_exp_f32 v230, v230
  v_exp_f32 v231, v231
  v_pk_add_f32 v[48:49], v[192:193], v[194:195]
  v_pk_add_f32 v[50:51], v[196:197], v[198:199]
  v_pk_add_f32 v[52:53], v[200:201], v[202:203]
  v_pk_add_f32 v[54:55], v[204:205], v[206:207]
  v_pk_add_f32 v[56:57], v[212:213], v[214:215]
  v_pk_add_f32 v[58:59], v[216:217], v[218:219]
  v_pk_add_f32 v[60:61], v[220:221], v[222:223]
  v_pk_add_f32 v[62:63], v[224:225], v[226:227]
  v_pk_add_f32 v[48:49], v[48:49], v[50:51]
  v_pk_add_f32 v[52:53], v[52:53], v[54:55]
  v_pk_add_f32 v[50:51], v[208:209], v[210:211]
  v_pk_add_f32 v[56:57], v[56:57], v[58:59]
  v_pk_add_f32 v[60:61], v[60:61], v[62:63]
  v_pk_add_f32 v[58:59], v[228:229], v[230:231]
  v_pk_add_f32 v[48:49], v[48:49], v[52:53]
  v_pk_add_f32 v[56:57], v[56:57], v[60:61]
  v_pk_add_f32 v[48:49], v[48:49], v[50:51]
  v_pk_add_f32 v[56:57], v[56:57], v[58:59]
  v_add_f32 v48, v48, v49
  v_add_f32 v56, v56, v57
  v_rcp_f32 v10, v48
  v_rcp_f32 v12, v56
  v_pk_mul_f32 v[192:193], v[192:193], v[10:11] op_sel_hi:[1,0]
  v_pk_mul_f32 v[212:213], v[212:213], v[12:13] op_sel_hi:[1,0]
  v_pk_mul_f32 v[194:195], v[194:195], v[10:11] op_sel_hi:[1,0]
  v_pk_mul_f32 v[214:215], v[214:215], v[12:13] op_sel_hi:[1,0]
  v_pk_mul_f32 v[196:197], v[196:197], v[10:11] op_sel_hi:[1,0]
  v_pk_mul_f32 v[216:217], v[216:217], v[12:13] op_sel_hi:[1,0]
  v_pk_mul_f32 v[198:199], v[198:199], v[10:11] op_sel_hi:[1,0]
  v_pk_mul_f32 v[218:219], v[218:219], v[12:13] op_sel_hi:[1,0]
  v_pk_mul_f32 v[200:201], v[200:201], v[10:11] op_sel_hi:[1,0]
  v_pk_mul_f32 v[220:221], v[220:221], v[12:13] op_sel_hi:[1,0]
  v_pk_mul_f32 v[202:203], v[202:203], v[10:11] op_sel_hi:[1,0]
  v_pk_mul_f32 v[222:223], v[222:223], v[12:13] op_sel_hi:[1,0]
  v_pk_mul_f32 v[204:205], v[204:205], v[10:11] op_sel_hi:[1,0]
  v_pk_mul_f32 v[224:225], v[224:225], v[12:13] op_sel_hi:[1,0]
  v_pk_mul_f32 v[206:207], v[206:207], v[10:11] op_sel_hi:[1,0]
  v_pk_mul_f32 v[226:227], v[226:227], v[12:13] op_sel_hi:[1,0]
  v_pk_mul_f32 v[208:209], v[208:209], v[10:11] op_sel_hi:[1,0]
  v_pk_mul_f32 v[228:229], v[228:229], v[12:13] op_sel_hi:[1,0]
  v_pk_mul_f32 v[210:211], v[210:211], v[10:11] op_sel_hi:[1,0]
  v_pk_mul_f32 v[230:231], v[230:231], v[12:13] op_sel_hi:[1,0]
  v_cvt_pk_bf16_f32 v192, v192, v193
  v_cvt_pk_bf16_f32 v193, v194, v195
  v_cvt_pk_bf16_f32 v194, v196, v197
  v_cvt_pk_bf16_f32 v195, v198, v199
  v_cvt_pk_bf16_f32 v196, v200, v201
  v_cvt_pk_bf16_f32 v197, v202, v203
  v_cvt_pk_bf16_f32 v198, v204, v205
  v_cvt_pk_bf16_f32 v199, v206, v207
  v_cvt_pk_bf16_f32 v200, v208, v209
  v_cvt_pk_bf16_f32 v201, v210, v211
  v_cvt_pk_bf16_f32 v202, v212, v213
  v_cvt_pk_bf16_f32 v203, v214, v215
  v_cvt_pk_bf16_f32 v204, v216, v217
  v_cvt_pk_bf16_f32 v205, v218, v219
  v_cvt_pk_bf16_f32 v206, v220, v221
  v_cvt_pk_bf16_f32 v207, v222, v223
  v_cvt_pk_bf16_f32 v208, v224, v225
  v_cvt_pk_bf16_f32 v209, v226, v227
  v_cvt_pk_bf16_f32 v210, v228, v229
  v_cvt_pk_bf16_f32 v211, v230, v231
  v_xor_b32 v8, 0, v7
  v_lshl_add_u32 v8, v8, 3, v14
  ds_write_b64 v8, v[192:193] offset:0
  v_xor_b32 v8, 1, v7
  v_lshl_add_u32 v8, v8, 3, v14
  ds_write_b64 v8, v[194:195] offset:0
  v_xor_b32 v8, 2, v7
  v_lshl_add_u32 v8, v8, 3, v14
  ds_write_b64 v8, v[196:197] offset:0
  v_xor_b32 v8, 3, v7
  v_lshl_add_u32 v8, v8, 3, v14
  ds_write_b64 v8, v[198:199] offset:0
  v_xor_b32 v8, 4, v7
  v_lshl_add_u32 v8, v8, 3, v14
  ds_write_b64 v8, v[200:201] offset:0
  v_xor_b32 v8, 5, v7
  v_lshl_add_u32 v8, v8, 3, v14
  ds_write_b64 v8, v[202:203] offset:0
  v_xor_b32 v8, 6, v7
  v_lshl_add_u32 v8, v8, 3, v14
  ds_write_b64 v8, v[204:205] offset:0
  v_xor_b32 v8, 7, v7
  v_lshl_add_u32 v8, v8, 3, v14
  ds_write_b64 v8, v[206:207] offset:0
  v_xor_b32 v8, 0, v7
  v_lshl_add_u32 v8, v8, 3, v14
  ds_write_b64 v8, v[208:209] offset:64
  v_xor_b32 v8, 1, v7
  v_lshl_add_u32 v8, v8, 3, v14
  ds_write_b64 v8, v[210:211] offset:64
  v_mov_b32 v10, 0x3f80
  v_mov_b32 v11, 0
  v_mul_u32_u24 v12, 3, v3
  v_cndmask_b32 v174, v174, v10, vcc
  v_cndmask_b32 v175, v175, v11, vcc
  v_cndmask_b32 v190, v190, v10, vcc
  v_cndmask_b32 v191, v191, v11, vcc
  v_add_u32 v8, 0, v12
  v_xor_b32 v8, v8, v7
  v_lshlrev_b32 v8, 3, v8
  v_add_u32 v9, v8, v5
  ds_write_b64 v9, v[170:171] offset:128
  v_add_u32 v9, v8, v6
  ds_write_b64 v9, v[186:187] offset:128
  v_add_u32 v8, 1, v12
  v_xor_b32 v8, v8, v7
  v_lshlrev_b32 v8, 3, v8
  v_add_u32 v9, v8, v5
  ds_write_b64 v9, v[172:173] offset:128
  v_add_u32 v9, v8, v6
  ds_write_b64 v9, v[188:189] offset:128
  v_add_u32 v8, 2, v12
  v_xor_b32 v8, v8, v7
  v_lshlrev_b32 v8, 3, v8
  v_add_u32 v9, v8, v5
  ds_write_b64 v9, v[174:175] offset:128
  v_add_u32 v9, v8, v6
  ds_write_b64 v9, v[190:191] offset:128
  s_waitcnt lgkmcnt(0)
  s_lshl_b32 s34, s3, 2
  s_add_u32 s34, s34, 160800
  s_xor_b32 s35, s3, 2
  s_lshl_b32 s35, s35, 2
  s_add_u32 s35, s35, 160800
  v_mov_b32 v8, s34
  v_mov_b32 v9, 1
  v_mov_b32 v10, s35
  ds_write_b32 v8, v9
Lpair_22:
  ds_read_b32 v9, v10
  s_waitcnt lgkmcnt(0)
  v_readfirstlane_b32 s34, v9
  s_nop 0
  s_cmp_eq_u32 s34, 1
  s_cbranch_scc0 Lpair_22
  v_lshrrev_b32 v4, 4, v1
  v_bfe_u32 v5, v1, 2, 2
  v_and_b32 v6, 3, v1
  v_lshrrev_b32 v8, 1, v4
  v_lshlrev_b32 v9, 3, v8
  v_add_u32 v9, v9, v5
  v_and_b32 v10, 1, v4
  v_lshl_add_u32 v10, v10, 2, v6
  s_mul_i32 s34, s27, 24576
  v_add_u32 v11, 0, v9
  v_bfe_u32 v12, v11, 1, 3
  v_xor_b32 v12, v12, v10
  v_mul_u32_u24 v11, 192, v11
  v_lshl_add_u32 v11, v12, 3, v11
  v_add_u32 v13, s34, v11
  v_add_u32 v11, 4, v9
  v_bfe_u32 v12, v11, 1, 3
  v_xor_b32 v12, v12, v10
  v_mul_u32_u24 v11, 192, v11
  v_lshl_add_u32 v11, v12, 3, v11
  v_add_u32 v14, s34, v11
  s_lshl_b32 s35, s26, 6
  v_add_u32 v15, s35, v13
  v_add_u32 v2, s35, v14
  ds_read_b64_tr_b16 v[160:161], v15 offset:0
  ds_read_b64_tr_b16 v[162:163], v2 offset:0
  ds_read_b64_tr_b16 v[192:193], v13 offset:128
  ds_read_b64_tr_b16 v[194:195], v14 offset:128
  ds_read_b64_tr_b16 v[164:165], v15 offset:3072
  ds_read_b64_tr_b16 v[166:167], v2 offset:3072
  ds_read_b64_tr_b16 v[196:197], v13 offset:3200
  ds_read_b64_tr_b16 v[198:199], v14 offset:3200
  ds_read_b64_tr_b16 v[168:169], v15 offset:6144
  ds_read_b64_tr_b16 v[170:171], v2 offset:6144
  ds_read_b64_tr_b16 v[200:201], v13 offset:6272
  ds_read_b64_tr_b16 v[202:203], v14 offset:6272
  s_waitcnt lgkmcnt(8)
  v_mfma_f32_32x32x16_bf16 v[48:63], v[160:163], v[192:195], 0
  ds_read_b64_tr_b16 v[172:173], v15 offset:9216
  ds_read_b64_tr_b16 v[174:175], v2 offset:9216
  ds_read_b64_tr_b16 v[204:205], v13 offset:9344
  ds_read_b64_tr_b16 v[206:207], v14 offset:9344
  s_waitcnt lgkmcnt(8)
  v_mfma_f32_32x32x16_bf16 v[48:63], v[164:167], v[196:199], v[48:63]
  ds_read_b64_tr_b16 v[176:177], v15 offset:12288
  ds_read_b64_tr_b16 v[178:179], v2 offset:12288
  ds_read_b64_tr_b16 v[208:209], v13 offset:12416
  ds_read_b64_tr_b16 v[210:211], v14 offset:12416
  s_waitcnt lgkmcnt(8)
  v_mfma_f32_32x32x16_bf16 v[48:63], v[168:171], v[200:203], v[48:63]
  ds_read_b64_tr_b16 v[180:181], v15 offset:15360
  ds_read_b64_tr_b16 v[182:183], v2 offset:15360
  ds_read_b64_tr_b16 v[212:213], v13 offset:15488
  ds_read_b64_tr_b16 v[214:215], v14 offset:15488
  s_waitcnt lgkmcnt(8)
  v_mfma_f32_32x32x16_bf16 v[48:63], v[172:175], v[204:207], v[48:63]
  ds_read_b64_tr_b16 v[184:185], v15 offset:18432
  ds_read_b64_tr_b16 v[186:187], v2 offset:18432
  ds_read_b64_tr_b16 v[216:217], v13 offset:18560
  ds_read_b64_tr_b16 v[218:219], v14 offset:18560
  s_waitcnt lgkmcnt(8)
  v_mfma_f32_32x32x16_bf16 v[48:63], v[176:179], v[208:211], v[48:63]
  ds_read_b64_tr_b16 v[188:189], v15 offset:21504
  ds_read_b64_tr_b16 v[190:191], v2 offset:21504
  ds_read_b64_tr_b16 v[220:221], v13 offset:21632
  ds_read_b64_tr_b16 v[222:223], v14 offset:21632
  s_waitcnt lgkmcnt(8)
  v_mfma_f32_32x32x16_bf16 v[48:63], v[180:183], v[212:215], v[48:63]
  s_waitcnt lgkmcnt(4)
  v_mfma_f32_32x32x16_bf16 v[48:63], v[184:187], v[216:219], v[48:63]
  s_waitcnt lgkmcnt(0)
  v_mfma_f32_32x32x16_bf16 v[48:63], v[188:191], v[220:223], v[48:63]
  v_and_b32 v2, 31, v1
  v_lshrrev_b32 v3, 5, v1
  v_mul_u32_u24 v4, 24, v3
  v_add_u32 v4, v4, v2
  v_lshlrev_b32 v4, 3, v4
  s_lshl_b32 s34, s5, 4
  s_add_u32 s34, s34, s4
  s_mul_i32 s34, s34, 3840
  s_mul_i32 s35, s27, 1920
  s_add_u32 s34, s34, s35
  s_mul_i32 s35, s26, 1536
  s_add_u32 s34, s34, s35
  s_add_u32 s34, s34, 6291456
  v_cmp_gt_u32 vcc, 24, v2
  s_nop 0
  s_and_saveexec_b64 s[36:37], vcc
  v_cvt_pk_bf16_f32 v64, v48, v49
  v_cvt_pk_bf16_f32 v65, v50, v51
  v_cvt_pk_bf16_f32 v66, v52, v53
  v_cvt_pk_bf16_f32 v67, v54, v55
  v_cvt_pk_bf16_f32 v68, v56, v57
  v_cvt_pk_bf16_f32 v69, v58, v59
  v_cvt_pk_bf16_f32 v70, v60, v61
  v_cvt_pk_bf16_f32 v71, v62, v63
  buffer_store_dwordx2 v[64:65], v4, s[20:23], s34 offen sc1
  s_cmp_eq_u32 s26, 0
  s_cbranch_scc0 Lkvd_23
  buffer_store_dwordx2 v[66:67], v4, s[20:23], s34 offen offset:384 sc1
  buffer_store_dwordx2 v[68:69], v4, s[20:23], s34 offen offset:768 sc1
  buffer_store_dwordx2 v[70:71], v4, s[20:23], s34 offen offset:1152 sc1
Lkvd_23:
  s_mov_b64 exec, s[36:37]
  v_max3_f32 v192, v16, v17, v18
  v_max3_f32 v193, v19, v20, v21
  v_max3_f32 v194, v22, v23, v24
  v_max3_f32 v195, v25, v26, v27
  v_max3_f32 v196, v28, v29, v30
  v_max3_f32 v197, v31, v32, v33
  v_max3_f32 v198, v34, v35, v192
  v_max3_f32 v199, v193, v194, v195
  v_max3_f32 v200, v196, v197, v198
  v_max_f32 v10, v199, v200
  v_min3_f32 v202, v16, v17, v18
  v_min3_f32 v203, v19, v20, v21
  v_min3_f32 v204, v22, v23, v24
  v_min3_f32 v205, v25, v26, v27
  v_min3_f32 v206, v28, v29, v30
  v_min3_f32 v207, v31, v32, v33
  v_min3_f32 v208, v34, v35, v202
  v_min3_f32 v209, v203, v204, v205
  v_min3_f32 v210, v206, v207, v208
  v_min_f32 v12, v209, v210
  v_mul_f32 v10, 0xbfb8aa3b, v10
  v_mul_f32 v12, 0x3fb8aa3b, v12
  v_pk_fma_f32 v[192:193], v[16:17], s[38:39], v[10:11] op_sel_hi:[1,1,0]
  v_pk_fma_f32 v[212:213], v[16:17], s[38:39], v[12:13] op_sel_hi:[1,1,0] neg_lo:[1,0,0] neg_hi:[1,0,0]
  v_pk_fma_f32 v[194:195], v[18:19], s[38:39], v[10:11] op_sel_hi:[1,1,0]
  v_pk_fma_f32 v[214:215], v[18:19], s[38:39], v[12:13] op_sel_hi:[1,1,0] neg_lo:[1,0,0] neg_hi:[1,0,0]
  v_pk_fma_f32 v[196:197], v[20:21], s[38:39], v[10:11] op_sel_hi:[1,1,0]
  v_pk_fma_f32 v[216:217], v[20:21], s[38:39], v[12:13] op_sel_hi:[1,1,0] neg_lo:[1,0,0] neg_hi:[1,0,0]
  v_pk_fma_f32 v[198:199], v[22:23], s[38:39], v[10:11] op_sel_hi:[1,1,0]
  v_pk_fma_f32 v[218:219], v[22:23], s[38:39], v[12:13] op_sel_hi:[1,1,0] neg_lo:[1,0,0] neg_hi:[1,0,0]
  v_pk_fma_f32 v[200:201], v[24:25], s[38:39], v[10:11] op_sel_hi:[1,1,0]
  v_pk_fma_f32 v[220:221], v[24:25], s[38:39], v[12:13] op_sel_hi:[1,1,0] neg_lo:[1,0,0] neg_hi:[1,0,0]
  v_pk_fma_f32 v[202:203], v[26:27], s[38:39], v[10:11] op_sel_hi:[1,1,0]
  v_pk_fma_f32 v[222:223], v[26:27], s[38:39], v[12:13] op_sel_hi:[1,1,0] neg_lo:[1,0,0] neg_hi:[1,0,0]
  v_pk_fma_f32 v[204:205], v[28:29], s[38:39], v[10:11] op_sel_hi:[1,1,0]
  v_pk_fma_f32 v[224:225], v[28:29], s[38:39], v[12:13] op_sel_hi:[1,1,0] neg_lo:[1,0,0] neg_hi:[1,0,0]
  v_pk_fma_f32 v[206:207], v[30:31], s[38:39], v[10:11] op_sel_hi:[1,1,0]
  v_pk_fma_f32 v[226:227], v[30:31], s[38:39], v[12:13] op_sel_hi:[1,1,0] neg_lo:[1,0,0] neg_hi:[1,0,0]
  v_pk_fma_f32 v[208:209], v[32:33], s[38:39], v[10:11] op_sel_hi:[1,1,0]
  v_pk_fma_f32 v[228:229], v[32:33], s[38:39], v[12:13] op_sel_hi:[1,1,0] neg_lo:[1,0,0] neg_hi:[1,0,0]
  v_pk_fma_f32 v[210:211], v[34:35], s[38:39], v[10:11] op_sel_hi:[1,1,0]
  v_pk_fma_f32 v[230:231], v[34:35], s[38:39], v[12:13] op_sel_hi:[1,1,0] neg_lo:[1,0,0] neg_hi:[1,0,0]
  v_exp_f32 v192, v192
  v_exp_f32 v193, v193
  v_exp_f32 v194, v194
  v_exp_f32 v195, v195
  v_exp_f32 v196, v196
  v_exp_f32 v197, v197
  v_exp_f32 v198, v198
  v_exp_f32 v199, v199
  v_exp_f32 v200, v200
  v_exp_f32 v201, v201
  v_exp_f32 v202, v202
  v_exp_f32 v203, v203
  v_exp_f32 v204, v204
  v_exp_f32 v205, v205
  v_exp_f32 v206, v206
  v_exp_f32 v207, v207
  v_exp_f32 v208, v208
  v_exp_f32 v209, v209
  v_exp_f32 v210, v210
  v_exp_f32 v211, v211
  v_exp_f32 v212, v212
  v_exp_f32 v213, v213
  v_exp_f32 v214, v214
  v_exp_f32 v215, v215
  v_exp_f32 v216, v216
  v_exp_f32 v217, v217
  v_exp_f32 v218, v218
  v_exp_f32 v219, v219
  v_exp_f32 v220, v220
  v_exp_f32 v221, v221
  v_exp_f32 v222, v222
  v_exp_f32 v223, v223
  v_exp_f32 v224, v224
  v_exp_f32 v225, v225
  v_exp_f32 v226, v226
  v_exp_f32 v227, v227
  v_exp_f32 v228, v228
  v_exp_f32 v229, v229
  v_exp_f32 v230, v230
  v_exp_f32 v231, v231
  v_pk_add_f32 v[16:17], v[192:193], v[194:195]
  v_pk_add_f32 v[18:19], v[196:197], v[198:199]
  v_pk_add_f32 v[20:21], v[200:201], v[202:203]
  v_pk_add_f32 v[22:23], v[204:205], v[206:207]
  v_pk_add_f32 v[24:25], v[212:213], v[214:215]
  v_pk_add_f32 v[26:27], v[216:217], v[218:219]
  v_pk_add_f32 v[28:29], v[220:221], v[222:223]
  v_pk_add_f32 v[30:31], v[224:225], v[226:227]
  v_pk_add_f32 v[16:17], v[16:17], v[18:19]
  v_pk_add_f32 v[20:21], v[20:21], v[22:23]
  v_pk_add_f32 v[18:19], v[208:209], v[210:211]
  v_pk_add_f32 v[24:25], v[24:25], v[26:27]
  v_pk_add_f32 v[28:29], v[28:29], v[30:31]
  v_pk_add_f32 v[26:27], v[228:229], v[230:231]
  v_pk_add_f32 v[16:17], v[16:17], v[20:21]
  v_pk_add_f32 v[24:25], v[24:25], v[28:29]
  v_pk_add_f32 v[16:17], v[16:17], v[18:19]
  v_pk_add_f32 v[24:25], v[24:25], v[26:27]
  v_add_f32 v16, v16, v17
  v_add_f32 v24, v24, v25
  v_rcp_f32 v10, v16
  v_rcp_f32 v12, v24
  v_pk_mul_f32 v[192:193], v[192:193], v[10:11] op_sel_hi:[1,0]
  v_pk_mul_f32 v[212:213], v[212:213], v[12:13] op_sel_hi:[1,0]
  v_pk_mul_f32 v[194:195], v[194:195], v[10:11] op_sel_hi:[1,0]
  v_pk_mul_f32 v[214:215], v[214:215], v[12:13] op_sel_hi:[1,0]
  v_pk_mul_f32 v[196:197], v[196:197], v[10:11] op_sel_hi:[1,0]
  v_pk_mul_f32 v[216:217], v[216:217], v[12:13] op_sel_hi:[1,0]
  v_pk_mul_f32 v[198:199], v[198:199], v[10:11] op_sel_hi:[1,0]
  v_pk_mul_f32 v[218:219], v[218:219], v[12:13] op_sel_hi:[1,0]
  v_pk_mul_f32 v[200:201], v[200:201], v[10:11] op_sel_hi:[1,0]
  v_pk_mul_f32 v[220:221], v[220:221], v[12:13] op_sel_hi:[1,0]
  v_pk_mul_f32 v[202:203], v[202:203], v[10:11] op_sel_hi:[1,0]
  v_pk_mul_f32 v[222:223], v[222:223], v[12:13] op_sel_hi:[1,0]
  v_pk_mul_f32 v[204:205], v[204:205], v[10:11] op_sel_hi:[1,0]
  v_pk_mul_f32 v[224:225], v[224:225], v[12:13] op_sel_hi:[1,0]
  v_pk_mul_f32 v[206:207], v[206:207], v[10:11] op_sel_hi:[1,0]
  v_pk_mul_f32 v[226:227], v[226:227], v[12:13] op_sel_hi:[1,0]
  v_pk_mul_f32 v[208:209], v[208:209], v[10:11] op_sel_hi:[1,0]
  v_pk_mul_f32 v[228:229], v[228:229], v[12:13] op_sel_hi:[1,0]
  v_pk_mul_f32 v[210:211], v[210:211], v[10:11] op_sel_hi:[1,0]
  v_pk_mul_f32 v[230:231], v[230:231], v[12:13] op_sel_hi:[1,0]
  v_cvt_pk_bf16_f32 v192, v192, v193
  v_cvt_pk_bf16_f32 v193, v194, v195
  v_cvt_pk_bf16_f32 v194, v196, v197
  v_cvt_pk_bf16_f32 v195, v198, v199
  v_cvt_pk_bf16_f32 v196, v200, v201
  v_cvt_pk_bf16_f32 v197, v202, v203
  v_cvt_pk_bf16_f32 v198, v204, v205
  v_cvt_pk_bf16_f32 v199, v206, v207
  v_cvt_pk_bf16_f32 v200, v208, v209
  v_cvt_pk_bf16_f32 v201, v210, v211
  v_cvt_pk_bf16_f32 v202, v212, v213
  v_cvt_pk_bf16_f32 v203, v214, v215
  v_cvt_pk_bf16_f32 v204, v216, v217
  v_cvt_pk_bf16_f32 v205, v218, v219
  v_cvt_pk_bf16_f32 v206, v220, v221
  v_cvt_pk_bf16_f32 v207, v222, v223
  v_cvt_pk_bf16_f32 v208, v224, v225
  v_cvt_pk_bf16_f32 v209, v226, v227
  v_cvt_pk_bf16_f32 v210, v228, v229
  v_cvt_pk_bf16_f32 v211, v230, v231
  v_mov_b32 v212, 0
  v_mov_b32 v213, 0
  v_permlane32_swap_b32 v192, v202
  v_permlane32_swap_b32 v193, v203
  v_permlane32_swap_b32 v194, v204
  v_permlane32_swap_b32 v195, v205
  v_permlane32_swap_b32 v196, v206
  v_permlane32_swap_b32 v197, v207
  v_permlane32_swap_b32 v198, v208
  v_permlane32_swap_b32 v199, v209
  v_permlane32_swap_b32 v200, v210
  v_permlane32_swap_b32 v201, v211
  s_waitcnt vmcnt(0)
  s_barrier
  s_cmp_eq_u32 s3, 0
  s_cbranch_scc0 Lnw1_25
  s_lshl_b32 s38, s5, 11
  s_lshl_b32 s39, s4, 7
  s_add_u32 s39, s39, s38
  s_add_u32 s39, s39, 22020096
  v_mov_b32 v6, s56
  v_mov_b32 v7, s57
  v_mov_b32 v5, 0
  s_mov_b64 exec, 1
  buffer_store_dwordx2 v[6:7], v5, s[20:23], s39 offen sc1
  s_mov_b64 exec, -1
Lnw1_25:
  v_and_b32 v5, 15, v1
  v_lshrrev_b32 v6, 4, v1
  s_lshl_b32 s38, s4, 7
  s_lshl_b32 s39, s7, 6
  s_add_u32 s38, s38, s39
  s_lshl_b32 s39, s3, 4
  s_add_u32 s38, s38, s39
  s_mul_i32 s38, s38, 1280
  s_mul_i32 s39, s24, 160
  s_add_u32 s38, s38, s39
  v_mul_u32_u24 v5, 1280, v5
  v_lshl_add_u32 v5, v6, 3, v5
  buffer_load_dwordx2 v[244:245], v5, s[8:11], s38 offen offset:0
  buffer_load_dwordx2 v[246:247], v5, s[8:11], s38 offen offset:32
  buffer_load_dwordx2 v[248:249], v5, s[8:11], s38 offen offset:64
  buffer_load_dwordx2 v[250:251], v5, s[8:11], s38 offen offset:96
  buffer_load_dwordx2 v[252:253], v5, s[8:11], s38 offen offset:128
  s_cmp_eq_u32 s3, 1
  s_cbranch_scc0 Lnw0_24
  s_lshl_b32 s38, s6, 11
  s_add_u32 s38, s38, 22020096
  v_and_b32 v5, 15, v1
  v_lshlrev_b32 v5, 7, v5
  s_mov_b32 s40, 0
Lpoll_26:
  s_add_u32 s40, s40, 1
  s_cmp_gt_u32 s40, 1048576
  s_cbranch_scc1 Lpollx_27
  buffer_load_dwordx2 v[6:7], v5, s[20:23], s38 offen sc1
  s_waitcnt vmcnt(0)
  v_cmp_eq_u32 vcc, s56, v6
  v_cmp_eq_u32 s[42:43], s57, v7
  s_nop 0
  s_and_b64 vcc, vcc, s[42:43]
  s_cmp_eq_u64 vcc, -1
  s_cbranch_scc0 Lpoll_26
Lpollx_27:
Lnw0_24:
  s_barrier
  s_lshl_b32 s34, s6, 4
  s_mul_i32 s34, s34, 3840
  s_add_u32 s34, s34, 6291456
  v_lshlrev_b32 v4, 4, v0
  v_cmp_gt_u32 vcc, 240, v0
  s_nop 0
  s_and_saveexec_b64 s[36:37], vcc
  s_add_u32 s35, s34, 0
  buffer_load_dwordx4 v[100:103], v4, s[20:23], s35 offen sc1
  s_add_u32 s35, s34, 3840
  buffer_load_dwordx4 v[104:107], v4, s[20:23], s35 offen sc1
  s_add_u32 s35, s34, 7680
  buffer_load_dwordx4 v[108:111], v4, s[20:23], s35 offen sc1
  s_add_u32 s35, s34, 11520
  buffer_load_dwordx4 v[112:115], v4, s[20:23], s35 offen sc1
  s_add_u32 s35, s34, 15360
  buffer_load_dwordx4 v[116:119], v4, s[20:23], s35 offen sc1
  s_add_u32 s35, s34, 19200
  buffer_load_dwordx4 v[120:123], v4, s[20:23], s35 offen sc1
  s_add_u32 s35, s34, 23040
  buffer_load_dwordx4 v[124:127], v4, s[20:23], s35 offen sc1
  s_add_u32 s35, s34, 26880
  buffer_load_dwordx4 v[128:131], v4, s[20:23], s35 offen sc1
  s_add_u32 s35, s34, 30720
  buffer_load_dwordx4 v[132:135], v4, s[20:23], s35 offen sc1
  s_add_u32 s35, s34, 34560
  buffer_load_dwordx4 v[136:139], v4, s[20:23], s35 offen sc1
  s_add_u32 s35, s34, 38400
  buffer_load_dwordx4 v[140:143], v4, s[20:23], s35 offen sc1
  s_add_u32 s35, s34, 42240
  buffer_load_dwordx4 v[144:147], v4, s[20:23], s35 offen sc1
  s_add_u32 s35, s34, 46080
  buffer_load_dwordx4 v[148:151], v4, s[20:23], s35 offen sc1
  s_add_u32 s35, s34, 49920
  buffer_load_dwordx4 v[152:155], v4, s[20:23], s35 offen sc1
  s_add_u32 s35, s34, 53760
  buffer_load_dwordx4 v[156:159], v4, s[20:23], s35 offen sc1
  s_add_u32 s35, s34, 57600
  buffer_load_dwordx4 v[160:163], v4, s[20:23], s35 offen sc1
  v_lshlrev_b32 v13, 1, v0
  v_cmp_le_u32 vcc, 240, v13
  s_nop 1
  v_cndmask_b32 v5, 0, 1, vcc
  v_mul_u32_u24 v6, 240, v5
  v_sub_u32 v6, v13, v6
  v_mul_u32_u24 v7, 2731, v6
  v_lshrrev_b32 v7, 16, v7
  v_mul_u32_u24 v8, 24, v7
  v_sub_u32 v8, v6, v8
  v_cmp_le_u32 vcc, 5, v7
  s_nop 1
  v_cndmask_b32 v9, 0, 1, vcc
  v_mul_u32_u24 v10, 5, v9
  v_sub_u32 v10, v7, v10
  v_mul_u32_u24 v11, 3072, v5
  v_mul_u32_u24 v12, 48, v9
  v_add_u32 v11, v11, v12
  v_lshl_add_u32 v11, v10, 3, v11
  v_cmp_ge_u32 s[46:47], 20, v8
  v_cmp_eq_u32 vcc, 20, v8
  v_mov_b32 v12, 24
  s_nop 0
  v_cndmask_b32 v12, v8, v12, vcc
  v_mul_u32_u24 v12, 96, v12
  v_add_u32 v11, v11, v12
  v_add_u32 v14, 153600, v11
  s_mov_b64 s[38:39], vcc
  v_add_u32 v13, 1, v13
  v_cmp_le_u32 vcc, 240, v13
  s_nop 1
  v_cndmask_b32 v5, 0, 1, vcc
  v_mul_u32_u24 v6, 240, v5
  v_sub_u32 v6, v13, v6
  v_mul_u32_u24 v7, 2731, v6
  v_lshrrev_b32 v7, 16, v7
  v_mul_u32_u24 v8, 24, v7
  v_sub_u32 v8, v6, v8
  v_cmp_le_u32 vcc, 5, v7
  s_nop 1
  v_cndmask_b32 v9, 0, 1, vcc
  v_mul_u32_u24 v10, 5, v9
  v_sub_u32 v10, v7, v10
  v_mul_u32_u24 v11, 3072, v5
  v_mul_u32_u24 v12, 48, v9
  v_add_u32 v11, v11, v12
  v_lshl_add_u32 v11, v10, 3, v11
  v_cmp_ge_u32 s[48:49], 20, v8
  v_cmp_eq_u32 vcc, 20, v8
  v_mov_b32 v12, 24
  s_nop 0
  v_cndmask_b32 v12, v8, v12, vcc
  v_mul_u32_u24 v12, 96, v12
  v_add_u32 v11, v11, v12
  v_add_u32 v15, 153600, v11
  s_mov_b64 s[42:43], vcc
  s_waitcnt vmcnt(15)
  v_lshlrev_b32 v48, 16, v100
  v_and_b32 v49, 0xffff0000, v100
  v_lshlrev_b32 v50, 16, v101
  v_and_b32 v51, 0xffff0000, v101
  v_lshlrev_b32 v52, 16, v102
  v_and_b32 v53, 0xffff0000, v102
  v_lshlrev_b32 v54, 16, v103
  v_and_b32 v55, 0xffff0000, v103
  s_waitcnt vmcnt(14)
  v_lshlrev_b32 v56, 16, v104
  v_and_b32 v57, 0xffff0000, v104
  v_lshlrev_b32 v58, 16, v105
  v_and_b32 v59, 0xffff0000, v105
  v_lshlrev_b32 v60, 16, v106
  v_and_b32 v61, 0xffff0000, v106
  v_lshlrev_b32 v62, 16, v107
  v_and_b32 v63, 0xffff0000, v107
  v_pk_add_f32 v[48:49], v[48:49], v[56:57]
  v_pk_add_f32 v[50:51], v[50:51], v[58:59]
  v_pk_add_f32 v[52:53], v[52:53], v[60:61]
  v_pk_add_f32 v[54:55], v[54:55], v[62:63]
  s_waitcnt vmcnt(13)
  v_lshlrev_b32 v56, 16, v108
  v_and_b32 v57, 0xffff0000, v108
  v_lshlrev_b32 v58, 16, v109
  v_and_b32 v59, 0xffff0000, v109
  v_lshlrev_b32 v60, 16, v110
  v_and_b32 v61, 0xffff0000, v110
  v_lshlrev_b32 v62, 16, v111
  v_and_b32 v63, 0xffff0000, v111
  v_pk_add_f32 v[48:49], v[48:49], v[56:57]
  v_pk_add_f32 v[50:51], v[50:51], v[58:59]
  v_pk_add_f32 v[52:53], v[52:53], v[60:61]
  v_pk_add_f32 v[54:55], v[54:55], v[62:63]
  s_waitcnt vmcnt(12)
  v_lshlrev_b32 v56, 16, v112
  v_and_b32 v57, 0xffff0000, v112
  v_lshlrev_b32 v58, 16, v113
  v_and_b32 v59, 0xffff0000, v113
  v_lshlrev_b32 v60, 16, v114
  v_and_b32 v61, 0xffff0000, v114
  v_lshlrev_b32 v62, 16, v115
  v_and_b32 v63, 0xffff0000, v115
  v_pk_add_f32 v[48:49], v[48:49], v[56:57]
  v_pk_add_f32 v[50:51], v[50:51], v[58:59]
  v_pk_add_f32 v[52:53], v[52:53], v[60:61]
  v_pk_add_f32 v[54:55], v[54:55], v[62:63]
  s_waitcnt vmcnt(11)
  v_lshlrev_b32 v56, 16, v116
  v_and_b32 v57, 0xffff0000, v116
  v_lshlrev_b32 v58, 16, v117
  v_and_b32 v59, 0xffff0000, v117
  v_lshlrev_b32 v60, 16, v118
  v_and_b32 v61, 0xffff0000, v118
  v_lshlrev_b32 v62, 16, v119
  v_and_b32 v63, 0xffff0000, v119
  v_pk_add_f32 v[48:49], v[48:49], v[56:57]
  v_pk_add_f32 v[50:51], v[50:51], v[58:59]
  v_pk_add_f32 v[52:53], v[52:53], v[60:61]
  v_pk_add_f32 v[54:55], v[54:55], v[62:63]
  s_waitcnt vmcnt(10)
  v_lshlrev_b32 v56, 16, v120
  v_and_b32 v57, 0xffff0000, v120
  v_lshlrev_b32 v58, 16, v121
  v_and_b32 v59, 0xffff0000, v121
  v_lshlrev_b32 v60, 16, v122
  v_and_b32 v61, 0xffff0000, v122
  v_lshlrev_b32 v62, 16, v123
  v_and_b32 v63, 0xffff0000, v123
  v_pk_add_f32 v[48:49], v[48:49], v[56:57]
  v_pk_add_f32 v[50:51], v[50:51], v[58:59]
  v_pk_add_f32 v[52:53], v[52:53], v[60:61]
  v_pk_add_f32 v[54:55], v[54:55], v[62:63]
  s_waitcnt vmcnt(9)
  v_lshlrev_b32 v56, 16, v124
  v_and_b32 v57, 0xffff0000, v124
  v_lshlrev_b32 v58, 16, v125
  v_and_b32 v59, 0xffff0000, v125
  v_lshlrev_b32 v60, 16, v126
  v_and_b32 v61, 0xffff0000, v126
  v_lshlrev_b32 v62, 16, v127
  v_and_b32 v63, 0xffff0000, v127
  v_pk_add_f32 v[48:49], v[48:49], v[56:57]
  v_pk_add_f32 v[50:51], v[50:51], v[58:59]
  v_pk_add_f32 v[52:53], v[52:53], v[60:61]
  v_pk_add_f32 v[54:55], v[54:55], v[62:63]
  s_waitcnt vmcnt(8)
  v_lshlrev_b32 v56, 16, v128
  v_and_b32 v57, 0xffff0000, v128
  v_lshlrev_b32 v58, 16, v129
  v_and_b32 v59, 0xffff0000, v129
  v_lshlrev_b32 v60, 16, v130
  v_and_b32 v61, 0xffff0000, v130
  v_lshlrev_b32 v62, 16, v131
  v_and_b32 v63, 0xffff0000, v131
  v_pk_add_f32 v[48:49], v[48:49], v[56:57]
  v_pk_add_f32 v[50:51], v[50:51], v[58:59]
  v_pk_add_f32 v[52:53], v[52:53], v[60:61]
  v_pk_add_f32 v[54:55], v[54:55], v[62:63]
  s_waitcnt vmcnt(7)
  v_lshlrev_b32 v56, 16, v132
  v_and_b32 v57, 0xffff0000, v132
  v_lshlrev_b32 v58, 16, v133
  v_and_b32 v59, 0xffff0000, v133
  v_lshlrev_b32 v60, 16, v134
  v_and_b32 v61, 0xffff0000, v134
  v_lshlrev_b32 v62, 16, v135
  v_and_b32 v63, 0xffff0000, v135
  v_pk_add_f32 v[48:49], v[48:49], v[56:57]
  v_pk_add_f32 v[50:51], v[50:51], v[58:59]
  v_pk_add_f32 v[52:53], v[52:53], v[60:61]
  v_pk_add_f32 v[54:55], v[54:55], v[62:63]
  s_waitcnt vmcnt(6)
  v_lshlrev_b32 v56, 16, v136
  v_and_b32 v57, 0xffff0000, v136
  v_lshlrev_b32 v58, 16, v137
  v_and_b32 v59, 0xffff0000, v137
  v_lshlrev_b32 v60, 16, v138
  v_and_b32 v61, 0xffff0000, v138
  v_lshlrev_b32 v62, 16, v139
  v_and_b32 v63, 0xffff0000, v139
  v_pk_add_f32 v[48:49], v[48:49], v[56:57]
  v_pk_add_f32 v[50:51], v[50:51], v[58:59]
  v_pk_add_f32 v[52:53], v[52:53], v[60:61]
  v_pk_add_f32 v[54:55], v[54:55], v[62:63]
  s_waitcnt vmcnt(5)
  v_lshlrev_b32 v56, 16, v140
  v_and_b32 v57, 0xffff0000, v140
  v_lshlrev_b32 v58, 16, v141
  v_and_b32 v59, 0xffff0000, v141
  v_lshlrev_b32 v60, 16, v142
  v_and_b32 v61, 0xffff0000, v142
  v_lshlrev_b32 v62, 16, v143
  v_and_b32 v63, 0xffff0000, v143
  v_pk_add_f32 v[48:49], v[48:49], v[56:57]
  v_pk_add_f32 v[50:51], v[50:51], v[58:59]
  v_pk_add_f32 v[52:53], v[52:53], v[60:61]
  v_pk_add_f32 v[54:55], v[54:55], v[62:63]
  s_waitcnt vmcnt(4)
  v_lshlrev_b32 v56, 16, v144
  v_and_b32 v57, 0xffff0000, v144
  v_lshlrev_b32 v58, 16, v145
  v_and_b32 v59, 0xffff0000, v145
  v_lshlrev_b32 v60, 16, v146
  v_and_b32 v61, 0xffff0000, v146
  v_lshlrev_b32 v62, 16, v147
  v_and_b32 v63, 0xffff0000, v147
  v_pk_add_f32 v[48:49], v[48:49], v[56:57]
  v_pk_add_f32 v[50:51], v[50:51], v[58:59]
  v_pk_add_f32 v[52:53], v[52:53], v[60:61]
  v_pk_add_f32 v[54:55], v[54:55], v[62:63]
  s_waitcnt vmcnt(3)
  v_lshlrev_b32 v56, 16, v148
  v_and_b32 v57, 0xffff0000, v148
  v_lshlrev_b32 v58, 16, v149
  v_and_b32 v59, 0xffff0000, v149
  v_lshlrev_b32 v60, 16, v150
  v_and_b32 v61, 0xffff0000, v150
  v_lshlrev_b32 v62, 16, v151
  v_and_b32 v63, 0xffff0000, v151
  v_pk_add_f32 v[48:49], v[48:49], v[56:57]
  v_pk_add_f32 v[50:51], v[50:51], v[58:59]
  v_pk_add_f32 v[52:53], v[52:53], v[60:61]
  v_pk_add_f32 v[54:55], v[54:55], v[62:63]
  s_waitcnt vmcnt(2)
  v_lshlrev_b32 v56, 16, v152
  v_and_b32 v57, 0xffff0000, v152
  v_lshlrev_b32 v58, 16, v153
  v_and_b32 v59, 0xffff0000, v153
  v_lshlrev_b32 v60, 16, v154
  v_and_b32 v61, 0xffff0000, v154
  v_lshlrev_b32 v62, 16, v155
  v_and_b32 v63, 0xffff0000, v155
  v_pk_add_f32 v[48:49], v[48:49], v[56:57]
  v_pk_add_f32 v[50:51], v[50:51], v[58:59]
  v_pk_add_f32 v[52:53], v[52:53], v[60:61]
  v_pk_add_f32 v[54:55], v[54:55], v[62:63]
  s_waitcnt vmcnt(1)
  v_lshlrev_b32 v56, 16, v156
  v_and_b32 v57, 0xffff0000, v156
  v_lshlrev_b32 v58, 16, v157
  v_and_b32 v59, 0xffff0000, v157
  v_lshlrev_b32 v60, 16, v158
  v_and_b32 v61, 0xffff0000, v158
  v_lshlrev_b32 v62, 16, v159
  v_and_b32 v63, 0xffff0000, v159
  v_pk_add_f32 v[48:49], v[48:49], v[56:57]
  v_pk_add_f32 v[50:51], v[50:51], v[58:59]
  v_pk_add_f32 v[52:53], v[52:53], v[60:61]
  v_pk_add_f32 v[54:55], v[54:55], v[62:63]
  s_waitcnt vmcnt(0)
  v_lshlrev_b32 v56, 16, v160
  v_and_b32 v57, 0xffff0000, v160
  v_lshlrev_b32 v58, 16, v161
  v_and_b32 v59, 0xffff0000, v161
  v_lshlrev_b32 v60, 16, v162
  v_and_b32 v61, 0xffff0000, v162
  v_lshlrev_b32 v62, 16, v163
  v_and_b32 v63, 0xffff0000, v163
  v_pk_add_f32 v[48:49], v[48:49], v[56:57]
  v_pk_add_f32 v[50:51], v[50:51], v[58:59]
  v_pk_add_f32 v[52:53], v[52:53], v[60:61]
  v_pk_add_f32 v[54:55], v[54:55], v[62:63]
  v_cvt_pk_bf16_f32 v56, v48, v49
  v_cvt_pk_bf16_f32 v57, v50, v51
  v_cvt_pk_bf16_f32 v58, v52, v53
  v_cvt_pk_bf16_f32 v59, v54, v55
  s_mov_b64 s[40:41], exec
  s_and_b64 exec, s[40:41], s[46:47]
  s_cbranch_execz Lzr_28
  ds_write_b64 v14, v[56:57] offset:0
Lzr_28:
  s_and_b64 exec, s[40:41], s[48:49]
  s_cbranch_execz Lzr_29
  ds_write_b64 v15, v[58:59] offset:0
Lzr_29:
  s_and_b64 exec, s[40:41], s[38:39]
  s_cbranch_execz Lzr_30
  ds_write_b64 v14, v[56:57] offset:384
Lzr_30:
  s_and_b64 exec, s[40:41], s[42:43]
  s_cbranch_execz Lzr_31
  ds_write_b64 v15, v[58:59] offset:384
Lzr_31:
  s_mov_b64 exec, s[36:37]
  s_waitcnt lgkmcnt(0)
  s_barrier
  v_and_b32 v2, 31, v1
  v_lshrrev_b32 v3, 5, v1
  v_mul_u32_u24 v4, 96, v2
  v_mul_u32_u24 v5, 48, v3
  v_add_u32 v4, v4, v5
  s_mul_i32 s34, s27, 3072
  s_add_u32 s34, s34, 153600
  v_add_u32 v4, s34, v4
  ds_read_b128 v[64:67], v4 offset:0
  ds_read_b128 v[68:71], v4 offset:16
  ds_read_b128 v[72:75], v4 offset:32
  v_mov_b32 v6, 160768
  ds_read_b32 v10, v6
  s_waitcnt lgkmcnt(0)
  v_readfirstlane_b32 s25, v10
  v_mfma_f32_32x32x16_bf16 v[16:31], v[64:67], v[192:195], 0
  v_mfma_f32_32x32x16_bf16 v[16:31], v[68:71], v[196:199], v[16:31]
  v_mfma_f32_32x32x16_bf16 v[16:31], v[72:75], v[200:203], v[16:31]
  v_mfma_f32_32x32x16_bf16 v[32:47], v[64:67], v[202:205], 0
  v_mfma_f32_32x32x16_bf16 v[32:47], v[68:71], v[206:209], v[32:47]
  v_mfma_f32_32x32x16_bf16 v[32:47], v[72:75], v[210:213], v[32:47]
  v_lshrrev_b32 v5, 4, v2
  v_and_b32 v6, 15, v2
  v_mul_u32_u24 v7, 20480, v5
  v_lshl_add_u32 v7, v6, 4, v7
  v_lshl_add_u32 v8, v3, 8, v7
  s_lshl_b32 s34, s4, 3
  s_lshl_b32 s35, s26, 2
  s_add_u32 s34, s34, s35
  s_mul_i32 s34, s34, 20480
  s_add_u32 s34, s34, 7340032
  s_lshl_b32 s35, s6, 10
  s_add_u32 s40, s34, s35
  s_lshl_b32 s35, s27, 9
  s_add_u32 s40, s40, s35
  s_lshr_b32 s35, s6, 2
  s_add_u32 s35, s35, 16
  s_lshl_b32 s35, s35, 10
  s_add_u32 s41, s34, s35
  s_and_b32 s35, s6, 3
  s_lshl_b32 s35, s35, 8
  s_add_u32 s41, s41, s35
  s_lshl_b32 s35, s27, 3
  s_add_u32 s41, s41, s35
  s_mul_i32 s42, s27, 40960
  s_sub_u32 s43, 40960, s42
  v_add_f32 v10, 0x358637bd, v28
  v_rcp_f32 v10, v10
  s_nop 0
  v_pk_mul_f32 v[16:17], v[16:17], v[10:11] op_sel_hi:[1,0]
  v_pk_mul_f32 v[18:19], v[18:19], v[10:11] op_sel_hi:[1,0]
  v_pk_mul_f32 v[20:21], v[20:21], v[10:11] op_sel_hi:[1,0]
  v_pk_mul_f32 v[22:23], v[22:23], v[10:11] op_sel_hi:[1,0]
  v_pk_mul_f32 v[24:25], v[24:25], v[10:11] op_sel_hi:[1,0]
  v_pk_mul_f32 v[26:27], v[26:27], v[10:11] op_sel_hi:[1,0]
  v_cvt_pk_bf16_f32 v48, v16, v17
  v_cvt_pk_bf16_f32 v49, v18, v19
  v_cvt_pk_bf16_f32 v50, v20, v21
  v_cvt_pk_bf16_f32 v51, v22, v23
  v_cvt_pk_bf16_f32 v52, v24, v25
  v_cvt_pk_bf16_f32 v53, v26, v27
  v_add_f32 v10, 0x358637bd, v44
  v_rcp_f32 v10, v10
  s_nop 0
  v_pk_mul_f32 v[32:33], v[32:33], v[10:11] op_sel_hi:[1,0]
  v_pk_mul_f32 v[34:35], v[34:35], v[10:11] op_sel_hi:[1,0]
  v_pk_mul_f32 v[36:37], v[36:37], v[10:11] op_sel_hi:[1,0]
  v_pk_mul_f32 v[38:39], v[38:39], v[10:11] op_sel_hi:[1,0]
  v_pk_mul_f32 v[40:41], v[40:41], v[10:11] op_sel_hi:[1,0]
  v_pk_mul_f32 v[42:43], v[42:43], v[10:11] op_sel_hi:[1,0]
  v_cvt_pk_bf16_f32 v56, v32, v33
  v_cvt_pk_bf16_f32 v57, v34, v35
  v_cvt_pk_bf16_f32 v58, v36, v37
  v_cvt_pk_bf16_f32 v59, v38, v39
  v_cvt_pk_bf16_f32 v60, v40, v41
  v_cvt_pk_bf16_f32 v61, v42, v43
  s_cmp_eq_u32 s25, 0
  s_cbranch_scc1 Lslow_32
  s_add_u32 s35, s40, s42
  buffer_store_dwordx4 v[48:51], v8, s[20:23], s35 offen
  s_add_u32 s35, s41, s42
  s_mov_b32 exec_hi, 0
  buffer_store_dwordx2 v[52:53], v7, s[20:23], s35 offen
  s_mov_b64 exec, -1
  s_add_u32 s35, s40, s43
  buffer_store_dwordx4 v[56:59], v8, s[20:23], s35 offen
  s_add_u32 s35, s41, s43
  s_mov_b32 exec_hi, 0
  buffer_store_dwordx2 v[60:61], v7, s[20:23], s35 offen
  s_mov_b64 exec, -1
  s_branch Lend_33
Lslow_32:
  s_add_u32 s35, s40, s42
  buffer_store_dwordx4 v[48:51], v8, s[20:23], s35 offen sc1
  s_add_u32 s35, s41, s42
  s_mov_b32 exec_hi, 0
  buffer_store_dwordx2 v[52:53], v7, s[20:23], s35 offen sc1
  s_mov_b64 exec, -1
  s_add_u32 s35, s40, s43
  buffer_store_dwordx4 v[56:59], v8, s[20:23], s35 offen sc1
  s_add_u32 s35, s41, s43
  s_mov_b32 exec_hi, 0
  buffer_store_dwordx2 v[60:61], v7, s[20:23], s35 offen sc1
  s_mov_b64 exec, -1
Lend_33:
  s_waitcnt vmcnt(0)
  s_barrier
  s_cmp_eq_u32 s3, 0
  s_cbranch_scc0 Lnw1_35
  s_lshl_b32 s38, s4, 11
  s_lshl_b32 s39, s5, 7
  s_add_u32 s39, s39, s38
  s_add_u32 s39, s39, 22052864
  v_mov_b32 v6, s56
  v_mov_b32 v7, s57
  v_mov_b32 v5, 0
  s_mov_b64 exec, 1
  s_cmp_eq_u32 s25, 0
  s_cbranch_scc1 Lslow_36
  buffer_store_dwordx2 v[6:7], v5, s[20:23], s39 offen
  s_branch Lend_37
Lslow_36:
  buffer_store_dwordx2 v[6:7], v5, s[20:23], s39 offen sc1
Lend_37:
  s_mov_b64 exec, -1
Lnw1_35:
  s_cmp_eq_u32 s3, 1
  s_cbranch_scc0 Lnw0_34
  s_lshl_b32 s38, s4, 11
  s_add_u32 s38, s38, 22052864
  v_and_b32 v5, 15, v1
  v_lshlrev_b32 v5, 7, v5
  s_mov_b32 s40, 0
Lpoll_38:
  s_add_u32 s40, s40, 1
  s_cmp_gt_u32 s40, 1048576
  s_cbranch_scc1 Lpollx_39
  buffer_load_dwordx2 v[6:7], v5, s[20:23], s38 offen sc1
  s_waitcnt vmcnt(0)
  v_cmp_eq_u32 vcc, s56, v6
  v_cmp_eq_u32 s[42:43], s57, v7
  s_nop 0
  s_and_b64 vcc, vcc, s[42:43]
  s_cmp_eq_u64 vcc, -1
  s_cbranch_scc0 Lpoll_38
Lpollx_39:
Lnw0_34:
  s_barrier
  s_lshl_b32 s34, s4, 3
  s_lshl_b32 s35, s7, 2
  s_add_u32 s34, s34, s35
  s_add_u32 s34, s34, s3
  s_mul_i32 s34, s34, 20480
  s_add_u32 s34, s34, 7340032
  v_lshlrev_b32 v8, 4, v1
  s_add_u32 s35, s34, 16384
  buffer_load_dwordx4 v[164:167], v8, s[20:23], s35 offen sc1
  s_add_u32 s35, s34, 17408
  buffer_load_dwordx4 v[168:171], v8, s[20:23], s35 offen sc1
  s_add_u32 s35, s34, 18432
  buffer_load_dwordx4 v[172:175], v8, s[20:23], s35 offen sc1
  s_add_u32 s35, s34, 19456
  buffer_load_dwordx4 v[176:179], v8, s[20:23], s35 offen sc1
  s_add_u32 s35, s34, 0
  buffer_load_dwordx4 v[100:103], v8, s[20:23], s35 offen sc1
  s_add_u32 s35, s34, 1024
  buffer_load_dwordx4 v[104:107], v8, s[20:23], s35 offen sc1
  s_add_u32 s35, s34, 2048
  buffer_load_dwordx4 v[108:111], v8, s[20:23], s35 offen sc1
  s_add_u32 s35, s34, 3072
  buffer_load_dwordx4 v[112:115], v8, s[20:23], s35 offen sc1
  s_add_u32 s35, s34, 4096
  buffer_load_dwordx4 v[116:119], v8, s[20:23], s35 offen sc1
  s_add_u32 s35, s34, 5120
  buffer_load_dwordx4 v[120:123], v8, s[20:23], s35 offen sc1
  s_add_u32 s35, s34, 6144
  buffer_load_dwordx4 v[124:127], v8, s[20:23], s35 offen sc1
  s_add_u32 s35, s34, 7168
  buffer_load_dwordx4 v[128:131], v8, s[20:23], s35 offen sc1
  s_add_u32 s35, s34, 8192
  buffer_load_dwordx4 v[132:135], v8, s[20:23], s35 offen sc1
  s_add_u32 s35, s34, 9216
  buffer_load_dwordx4 v[136:139], v8, s[20:23], s35 offen sc1
  s_add_u32 s35, s34, 10240
  buffer_load_dwordx4 v[140:143], v8, s[20:23], s35 offen sc1
  s_add_u32 s35, s34, 11264
  buffer_load_dwordx4 v[144:147], v8, s[20:23], s35 offen sc1
  s_add_u32 s35, s34, 12288
  buffer_load_dwordx4 v[148:151], v8, s[20:23], s35 offen sc1
  s_add_u32 s35, s34, 13312
  buffer_load_dwordx4 v[152:155], v8, s[20:23], s35 offen sc1
  s_add_u32 s35, s34, 14336
  buffer_load_dwordx4 v[156:159], v8, s[20:23], s35 offen sc1
  s_add_u32 s35, s34, 15360
  buffer_load_dwordx4 v[160:163], v8, s[20:23], s35 offen sc1
  v_lshrrev_b32 v4, 4, v1
  v_bfe_u32 v5, v1, 2, 2
  v_and_b32 v6, 3, v1
  v_lshrrev_b32 v7, 1, v4
  v_mul_u32_u24 v7, 20, v7
  v_and_b32 v8, 1, v4
  v_lshl_add_u32 v7, v8, 2, v7
  v_add_u32 v7, v7, v5
  v_mul_u32_u24 v7, 160, v7
  v_lshl_add_u32 v72, v6, 3, v7
  v_add_u32 v72, 49664, v72
  v_add_u32 v73, 51200, v72
  v_mul_u32_u24 v7, 40, v4
  v_add_u32 v7, v7, v5
  v_add_u32 v7, 16, v7
  v_mul_u32_u24 v7, 160, v7
  v_lshl_add_u32 v74, v6, 3, v7
  v_add_u32 v74, 49664, v74
  v_add_u32 v75, 51200, v74
  v_lshlrev_b32 v72, 4, v1
  v_add_u32 v72, 49664, v72
  v_add_u32 v73, 51200, v72
  v_and_b32 v2, 15, v1
  v_lshrrev_b32 v4, 4, v1
  s_lshl_b32 s46, s4, 2
  s_lshl_b32 s35, s7, 1
  s_add_u32 s46, s46, s35
  s_lshr_b32 s35, s3, 1
  s_add_u32 s46, s46, s35
  s_mul_i32 s46, s46, 40
  s_mul_i32 s35, s24, 5
  s_add_u32 s46, s46, s35
  s_lshl_b32 s46, s46, 10
  s_add_u32 s46, s46, 10485760
  s_and_b32 s35, s3, 1
  s_lshl_b32 s35, s35, 8
  s_add_u32 s46, s46, s35
  v_lshrrev_b32 v6, 1, v4
  v_lshlrev_b32 v6, 9, v6
  v_lshl_add_u32 v6, v2, 4, v6
  v_and_b32 v7, 1, v4
  v_lshl_add_u32 v76, v7, 3, v6
  s_lshl_b32 s47, s4, 3
  s_add_u32 s47, s47, s24
  s_lshl_b32 s47, s47, 7
  s_lshl_b32 s35, s7, 6
  s_add_u32 s47, s47, s35
  s_lshl_b32 s35, s3, 4
  s_add_u32 s47, s47, s35
  s_lshl_b32 s47, s47, 3
  s_add_u32 s47, s47, 13631488
  v_lshlrev_b32 v77, 3, v2
  ds_read_b128 v[40:43], v73 offset:30720
  ds_read_b128 v[44:47], v73 offset:31744
  ds_read_b128 v[48:51], v73 offset:32768
  ds_read_b128 v[52:55], v73 offset:33792
  ds_read_b128 v[56:59], v73 offset:34816
  ds_read_b128 v[60:63], v73 offset:35840
  ds_read_b128 v[64:67], v73 offset:36864
  s_waitcnt vmcnt(19)
  s_waitcnt lgkmcnt(6)
  v_mfma_f32_16x16x32_bf16 v[16:19], v[40:43], v[164:167], 0
  ds_read_b128 v[68:71], v73 offset:37888
  s_waitcnt lgkmcnt(6)
  v_mfma_f32_16x16x32_bf16 v[20:23], v[44:47], v[164:167], 0
  ds_read_b128 v[40:43], v73 offset:38912
  s_waitcnt lgkmcnt(6)
  v_mfma_f32_16x16x32_bf16 v[24:27], v[48:51], v[164:167], 0
  ds_read_b128 v[44:47], v73 offset:39936
  s_waitcnt lgkmcnt(6)
  v_mfma_f32_16x16x32_bf16 v[28:31], v[52:55], v[164:167], 0
  ds_read_b128 v[48:51], v73 offset:40960
  s_waitcnt lgkmcnt(6)
  v_mfma_f32_16x16x32_bf16 v[32:35], v[56:59], v[164:167], 0
  ds_read_b128 v[52:55], v73 offset:41984
  s_waitcnt vmcnt(18)
  s_waitcnt lgkmcnt(6)
  v_mfma_f32_16x16x32_bf16 v[16:19], v[60:63], v[168:171], v[16:19]
  ds_read_b128 v[56:59], v73 offset:43008
  s_waitcnt lgkmcnt(6)
  v_mfma_f32_16x16x32_bf16 v[20:23], v[64:67], v[168:171], v[20:23]
  ds_read_b128 v[60:63], v73 offset:44032
  s_waitcnt lgkmcnt(6)
  v_mfma_f32_16x16x32_bf16 v[24:27], v[68:71], v[168:171], v[24:27]
  ds_read_b128 v[64:67], v73 offset:45056
  s_waitcnt lgkmcnt(6)
  v_mfma_f32_16x16x32_bf16 v[28:31], v[40:43], v[168:171], v[28:31]
  ds_read_b128 v[68:71], v73 offset:46080
  s_waitcnt lgkmcnt(6)
  v_mfma_f32_16x16x32_bf16 v[32:35], v[44:47], v[168:171], v[32:35]
  ds_read_b128 v[40:43], v73 offset:47104
  s_waitcnt vmcnt(17)
  s_waitcnt lgkmcnt(6)
  v_mfma_f32_16x16x32_bf16 v[16:19], v[48:51], v[172:175], v[16:19]
  ds_read_b128 v[44:47], v73 offset:48128
  s_waitcnt lgkmcnt(6)
  v_mfma_f32_16x16x32_bf16 v[20:23], v[52:55], v[172:175], v[20:23]
  ds_read_b128 v[48:51], v73 offset:49152
  s_waitcnt lgkmcnt(6)
  v_mfma_f32_16x16x32_bf16 v[24:27], v[56:59], v[172:175], v[24:27]
  ds_read_b128 v[52:55], v73 offset:50176
  s_waitcnt lgkmcnt(6)
  v_mfma_f32_16x16x32_bf16 v[28:31], v[60:63], v[172:175], v[28:31]
  ds_read_b128 v[56:59], v72 offset:0
  s_waitcnt lgkmcnt(6)
  v_mfma_f32_16x16x32_bf16 v[32:35], v[64:67], v[172:175], v[32:35]
  ds_read_b128 v[60:63], v72 offset:1024
  s_waitcnt vmcnt(16)
  s_waitcnt lgkmcnt(6)
  v_mfma_f32_16x16x32_bf16 v[16:19], v[68:71], v[176:179], v[16:19]
  ds_read_b128 v[64:67], v72 offset:2048
  s_waitcnt lgkmcnt(6)
  v_mfma_f32_16x16x32_bf16 v[20:23], v[40:43], v[176:179], v[20:23]
  ds_read_b128 v[68:71], v72 offset:3072
  s_waitcnt lgkmcnt(6)
  v_mfma_f32_16x16x32_bf16 v[24:27], v[44:47], v[176:179], v[24:27]
  ds_read_b128 v[40:43], v72 offset:4096
  s_waitcnt lgkmcnt(6)
  v_mfma_f32_16x16x32_bf16 v[28:31], v[48:51], v[176:179], v[28:31]
  ds_read_b128 v[44:47], v72 offset:5120
  s_waitcnt lgkmcnt(6)
  v_mfma_f32_16x16x32_bf16 v[32:35], v[52:55], v[176:179], v[32:35]
  ds_read_b128 v[48:51], v72 offset:6144
  s_waitcnt vmcnt(15)
  s_waitcnt lgkmcnt(6)
  v_mfma_f32_16x16x32_bf16 v[16:19], v[56:59], v[100:103], v[16:19]
  ds_read_b128 v[52:55], v72 offset:7168
  s_waitcnt lgkmcnt(6)
  v_mfma_f32_16x16x32_bf16 v[20:23], v[60:63], v[100:103], v[20:23]
  ds_read_b128 v[56:59], v72 offset:8192
  s_waitcnt lgkmcnt(6)
  v_mfma_f32_16x16x32_bf16 v[24:27], v[64:67], v[100:103], v[24:27]
  ds_read_b128 v[60:63], v72 offset:9216
  s_waitcnt lgkmcnt(6)
  v_mfma_f32_16x16x32_bf16 v[28:31], v[68:71], v[100:103], v[28:31]
  ds_read_b128 v[64:67], v72 offset:10240
  s_waitcnt lgkmcnt(6)
  v_mfma_f32_16x16x32_bf16 v[32:35], v[40:43], v[100:103], v[32:35]
  ds_read_b128 v[68:71], v72 offset:11264
  s_waitcnt vmcnt(14)
  s_waitcnt lgkmcnt(6)
  v_mfma_f32_16x16x32_bf16 v[16:19], v[44:47], v[104:107], v[16:19]
  ds_read_b128 v[40:43], v72 offset:12288
  s_waitcnt lgkmcnt(6)
  v_mfma_f32_16x16x32_bf16 v[20:23], v[48:51], v[104:107], v[20:23]
  ds_read_b128 v[44:47], v72 offset:13312
  s_waitcnt lgkmcnt(6)
  v_mfma_f32_16x16x32_bf16 v[24:27], v[52:55], v[104:107], v[24:27]
  ds_read_b128 v[48:51], v72 offset:14336
  s_waitcnt lgkmcnt(6)
  v_mfma_f32_16x16x32_bf16 v[28:31], v[56:59], v[104:107], v[28:31]
  ds_read_b128 v[52:55], v72 offset:15360
  s_waitcnt lgkmcnt(6)
  v_mfma_f32_16x16x32_bf16 v[32:35], v[60:63], v[104:107], v[32:35]
  ds_read_b128 v[56:59], v72 offset:16384
  s_waitcnt vmcnt(13)
  s_waitcnt lgkmcnt(6)
  v_mfma_f32_16x16x32_bf16 v[16:19], v[64:67], v[108:111], v[16:19]
  ds_read_b128 v[60:63], v72 offset:17408
  s_waitcnt lgkmcnt(6)
  v_mfma_f32_16x16x32_bf16 v[20:23], v[68:71], v[108:111], v[20:23]
  ds_read_b128 v[64:67], v72 offset:18432
  s_waitcnt lgkmcnt(6)
  v_mfma_f32_16x16x32_bf16 v[24:27], v[40:43], v[108:111], v[24:27]
  ds_read_b128 v[68:71], v72 offset:19456
  s_waitcnt lgkmcnt(6)
  v_mfma_f32_16x16x32_bf16 v[28:31], v[44:47], v[108:111], v[28:31]
  ds_read_b128 v[40:43], v72 offset:20480
  s_waitcnt lgkmcnt(6)
  v_mfma_f32_16x16x32_bf16 v[32:35], v[48:51], v[108:111], v[32:35]
  ds_read_b128 v[44:47], v72 offset:21504
  s_waitcnt vmcnt(12)
  s_waitcnt lgkmcnt(6)
  v_mfma_f32_16x16x32_bf16 v[16:19], v[52:55], v[112:115], v[16:19]
  ds_read_b128 v[48:51], v72 offset:22528
  s_waitcnt lgkmcnt(6)
  v_mfma_f32_16x16x32_bf16 v[20:23], v[56:59], v[112:115], v[20:23]
  ds_read_b128 v[52:55], v72 offset:23552
  s_waitcnt lgkmcnt(6)
  v_mfma_f32_16x16x32_bf16 v[24:27], v[60:63], v[112:115], v[24:27]
  ds_read_b128 v[56:59], v72 offset:24576
  s_waitcnt lgkmcnt(6)
  v_mfma_f32_16x16x32_bf16 v[28:31], v[64:67], v[112:115], v[28:31]
  ds_read_b128 v[60:63], v72 offset:25600
  s_waitcnt lgkmcnt(6)
  v_mfma_f32_16x16x32_bf16 v[32:35], v[68:71], v[112:115], v[32:35]
  ds_read_b128 v[64:67], v72 offset:26624
  s_waitcnt vmcnt(11)
  s_waitcnt lgkmcnt(6)
  v_mfma_f32_16x16x32_bf16 v[16:19], v[40:43], v[116:119], v[16:19]
  ds_read_b128 v[68:71], v72 offset:27648
  s_waitcnt lgkmcnt(6)
  v_mfma_f32_16x16x32_bf16 v[20:23], v[44:47], v[116:119], v[20:23]
  ds_read_b128 v[40:43], v72 offset:28672
  s_waitcnt lgkmcnt(6)
  v_mfma_f32_16x16x32_bf16 v[24:27], v[48:51], v[116:119], v[24:27]
  ds_read_b128 v[44:47], v72 offset:29696
  s_waitcnt lgkmcnt(6)
  v_mfma_f32_16x16x32_bf16 v[28:31], v[52:55], v[116:119], v[28:31]
  ds_read_b128 v[48:51], v72 offset:30720
  s_waitcnt lgkmcnt(6)
  v_mfma_f32_16x16x32_bf16 v[32:35], v[56:59], v[116:119], v[32:35]
  ds_read_b128 v[52:55], v72 offset:31744
  s_waitcnt vmcnt(10)
  s_waitcnt lgkmcnt(6)
  v_mfma_f32_16x16x32_bf16 v[16:19], v[60:63], v[120:123], v[16:19]
  ds_read_b128 v[56:59], v72 offset:32768
  s_waitcnt lgkmcnt(6)
  v_mfma_f32_16x16x32_bf16 v[20:23], v[64:67], v[120:123], v[20:23]
  ds_read_b128 v[60:63], v72 offset:33792
  s_waitcnt lgkmcnt(6)
  v_mfma_f32_16x16x32_bf16 v[24:27], v[68:71], v[120:123], v[24:27]
  ds_read_b128 v[64:67], v72 offset:34816
  s_waitcnt lgkmcnt(6)
  v_mfma_f32_16x16x32_bf16 v[28:31], v[40:43], v[120:123], v[28:31]
  ds_read_b128 v[68:71], v72 offset:35840
  s_waitcnt lgkmcnt(6)
  v_mfma_f32_16x16x32_bf16 v[32:35], v[44:47], v[120:123], v[32:35]
  ds_read_b128 v[40:43], v72 offset:36864
  s_waitcnt vmcnt(9)
  s_waitcnt lgkmcnt(6)
  v_mfma_f32_16x16x32_bf16 v[16:19], v[48:51], v[124:127], v[16:19]
  ds_read_b128 v[44:47], v72 offset:37888
  s_waitcnt lgkmcnt(6)
  v_mfma_f32_16x16x32_bf16 v[20:23], v[52:55], v[124:127], v[20:23]
  ds_read_b128 v[48:51], v72 offset:38912
  s_waitcnt lgkmcnt(6)
  v_mfma_f32_16x16x32_bf16 v[24:27], v[56:59], v[124:127], v[24:27]
  ds_read_b128 v[52:55], v72 offset:39936
  s_waitcnt lgkmcnt(6)
  v_mfma_f32_16x16x32_bf16 v[28:31], v[60:63], v[124:127], v[28:31]
  ds_read_b128 v[56:59], v72 offset:40960
  s_waitcnt lgkmcnt(6)
  v_mfma_f32_16x16x32_bf16 v[32:35], v[64:67], v[124:127], v[32:35]
  ds_read_b128 v[60:63], v72 offset:41984
  s_waitcnt vmcnt(8)
  s_waitcnt lgkmcnt(6)
  v_mfma_f32_16x16x32_bf16 v[16:19], v[68:71], v[128:131], v[16:19]
  ds_read_b128 v[64:67], v72 offset:43008
  s_waitcnt lgkmcnt(6)
  v_mfma_f32_16x16x32_bf16 v[20:23], v[40:43], v[128:131], v[20:23]
  ds_read_b128 v[68:71], v72 offset:44032
  s_waitcnt lgkmcnt(6)
  v_mfma_f32_16x16x32_bf16 v[24:27], v[44:47], v[128:131], v[24:27]
  ds_read_b128 v[40:43], v72 offset:45056
  s_waitcnt lgkmcnt(6)
  v_mfma_f32_16x16x32_bf16 v[28:31], v[48:51], v[128:131], v[28:31]
  ds_read_b128 v[44:47], v72 offset:46080
  s_waitcnt lgkmcnt(6)
  v_mfma_f32_16x16x32_bf16 v[32:35], v[52:55], v[128:131], v[32:35]
  ds_read_b128 v[48:51], v72 offset:47104
  s_waitcnt vmcnt(7)
  s_waitcnt lgkmcnt(6)
  v_mfma_f32_16x16x32_bf16 v[16:19], v[56:59], v[132:135], v[16:19]
  ds_read_b128 v[52:55], v72 offset:48128
  s_waitcnt lgkmcnt(6)
  v_mfma_f32_16x16x32_bf16 v[20:23], v[60:63], v[132:135], v[20:23]
  ds_read_b128 v[56:59], v72 offset:49152
  s_waitcnt lgkmcnt(6)
  v_mfma_f32_16x16x32_bf16 v[24:27], v[64:67], v[132:135], v[24:27]
  ds_read_b128 v[60:63], v72 offset:50176
  s_waitcnt lgkmcnt(6)
  v_mfma_f32_16x16x32_bf16 v[28:31], v[68:71], v[132:135], v[28:31]
  ds_read_b128 v[64:67], v73 offset:0
  s_waitcnt lgkmcnt(6)
  v_mfma_f32_16x16x32_bf16 v[32:35], v[40:43], v[132:135], v[32:35]
  ds_read_b128 v[68:71], v73 offset:1024
  s_waitcnt vmcnt(6)
  s_waitcnt lgkmcnt(6)
  v_mfma_f32_16x16x32_bf16 v[16:19], v[44:47], v[136:139], v[16:19]
  ds_read_b128 v[40:43], v73 offset:2048
  s_waitcnt lgkmcnt(6)
  v_mfma_f32_16x16x32_bf16 v[20:23], v[48:51], v[136:139], v[20:23]
  ds_read_b128 v[44:47], v73 offset:3072
  s_waitcnt lgkmcnt(6)
  v_mfma_f32_16x16x32_bf16 v[24:27], v[52:55], v[136:139], v[24:27]
  ds_read_b128 v[48:51], v73 offset:4096
  s_waitcnt lgkmcnt(6)
  v_mfma_f32_16x16x32_bf16 v[28:31], v[56:59], v[136:139], v[28:31]
  ds_read_b128 v[52:55], v73 offset:5120
  s_waitcnt lgkmcnt(6)
  v_mfma_f32_16x16x32_bf16 v[32:35], v[60:63], v[136:139], v[32:35]
  ds_read_b128 v[56:59], v73 offset:6144
  s_waitcnt vmcnt(5)
  s_waitcnt lgkmcnt(6)
  v_mfma_f32_16x16x32_bf16 v[16:19], v[64:67], v[140:143], v[16:19]
  ds_read_b128 v[60:63], v73 offset:7168
  s_waitcnt lgkmcnt(6)
  v_mfma_f32_16x16x32_bf16 v[20:23], v[68:71], v[140:143], v[20:23]
  ds_read_b128 v[64:67], v73 offset:8192
  s_waitcnt lgkmcnt(6)
  v_mfma_f32_16x16x32_bf16 v[24:27], v[40:43], v[140:143], v[24:27]
  ds_read_b128 v[68:71], v73 offset:9216
  s_waitcnt lgkmcnt(6)
  v_mfma_f32_16x16x32_bf16 v[28:31], v[44:47], v[140:143], v[28:31]
  ds_read_b128 v[40:43], v73 offset:10240
  s_waitcnt lgkmcnt(6)
  v_mfma_f32_16x16x32_bf16 v[32:35], v[48:51], v[140:143], v[32:35]
  ds_read_b128 v[44:47], v73 offset:11264
  s_waitcnt vmcnt(4)
  s_waitcnt lgkmcnt(6)
  v_mfma_f32_16x16x32_bf16 v[16:19], v[52:55], v[144:147], v[16:19]
  ds_read_b128 v[48:51], v73 offset:12288
  s_waitcnt lgkmcnt(6)
  v_mfma_f32_16x16x32_bf16 v[20:23], v[56:59], v[144:147], v[20:23]
  ds_read_b128 v[52:55], v73 offset:13312
  s_waitcnt lgkmcnt(6)
  v_mfma_f32_16x16x32_bf16 v[24:27], v[60:63], v[144:147], v[24:27]
  ds_read_b128 v[56:59], v73 offset:14336
  s_waitcnt lgkmcnt(6)
  v_mfma_f32_16x16x32_bf16 v[28:31], v[64:67], v[144:147], v[28:31]
  ds_read_b128 v[60:63], v73 offset:15360
  s_waitcnt lgkmcnt(6)
  v_mfma_f32_16x16x32_bf16 v[32:35], v[68:71], v[144:147], v[32:35]
  ds_read_b128 v[64:67], v73 offset:16384
  s_waitcnt vmcnt(3)
  s_waitcnt lgkmcnt(6)
  v_mfma_f32_16x16x32_bf16 v[16:19], v[40:43], v[148:151], v[16:19]
  ds_read_b128 v[68:71], v73 offset:17408
  s_waitcnt lgkmcnt(6)
  v_mfma_f32_16x16x32_bf16 v[20:23], v[44:47], v[148:151], v[20:23]
  ds_read_b128 v[40:43], v73 offset:18432
  s_waitcnt lgkmcnt(6)
  v_mfma_f32_16x16x32_bf16 v[24:27], v[48:51], v[148:151], v[24:27]
  ds_read_b128 v[44:47], v73 offset:19456
  s_waitcnt lgkmcnt(6)
  v_mfma_f32_16x16x32_bf16 v[28:31], v[52:55], v[148:151], v[28:31]
  ds_read_b128 v[48:51], v73 offset:20480
  s_waitcnt lgkmcnt(6)
  v_mfma_f32_16x16x32_bf16 v[32:35], v[56:59], v[148:151], v[32:35]
  ds_read_b128 v[52:55], v73 offset:21504
  s_waitcnt vmcnt(2)
  s_waitcnt lgkmcnt(6)
  v_mfma_f32_16x16x32_bf16 v[16:19], v[60:63], v[152:155], v[16:19]
  ds_read_b128 v[56:59], v73 offset:22528
  s_waitcnt lgkmcnt(6)
  v_mfma_f32_16x16x32_bf16 v[20:23], v[64:67], v[152:155], v[20:23]
  ds_read_b128 v[60:63], v73 offset:23552
  s_waitcnt lgkmcnt(6)
  v_mfma_f32_16x16x32_bf16 v[24:27], v[68:71], v[152:155], v[24:27]
  ds_read_b128 v[64:67], v73 offset:24576
  s_waitcnt lgkmcnt(6)
  v_mfma_f32_16x16x32_bf16 v[28:31], v[40:43], v[152:155], v[28:31]
  ds_read_b128 v[68:71], v73 offset:25600
  s_waitcnt lgkmcnt(6)
  v_mfma_f32_16x16x32_bf16 v[32:35], v[44:47], v[152:155], v[32:35]
  ds_read_b128 v[40:43], v73 offset:26624
  s_waitcnt vmcnt(1)
  s_waitcnt lgkmcnt(6)
  v_mfma_f32_16x16x32_bf16 v[16:19], v[48:51], v[156:159], v[16:19]
  ds_read_b128 v[44:47], v73 offset:27648
  s_waitcnt lgkmcnt(6)
  v_mfma_f32_16x16x32_bf16 v[20:23], v[52:55], v[156:159], v[20:23]
  ds_read_b128 v[48:51], v73 offset:28672
  s_waitcnt lgkmcnt(6)
  v_mfma_f32_16x16x32_bf16 v[24:27], v[56:59], v[156:159], v[24:27]
  ds_read_b128 v[52:55], v73 offset:29696
  s_waitcnt lgkmcnt(6)
  v_mfma_f32_16x16x32_bf16 v[28:31], v[60:63], v[156:159], v[28:31]
  s_waitcnt lgkmcnt(5)
  v_mfma_f32_16x16x32_bf16 v[32:35], v[64:67], v[156:159], v[32:35]
  s_waitcnt vmcnt(0)
  s_waitcnt lgkmcnt(4)
  v_mfma_f32_16x16x32_bf16 v[16:19], v[68:71], v[160:163], v[16:19]
  s_waitcnt lgkmcnt(3)
  v_mfma_f32_16x16x32_bf16 v[20:23], v[40:43], v[160:163], v[20:23]
  s_waitcnt lgkmcnt(2)
  v_mfma_f32_16x16x32_bf16 v[24:27], v[44:47], v[160:163], v[24:27]
  s_waitcnt lgkmcnt(1)
  v_mfma_f32_16x16x32_bf16 v[28:31], v[48:51], v[160:163], v[28:31]
  s_waitcnt lgkmcnt(0)
  v_mfma_f32_16x16x32_bf16 v[32:35], v[52:55], v[160:163], v[32:35]
  v_lshlrev_b32 v10, 16, v244
  v_and_b32 v11, 0xffff0000, v244
  v_pk_add_f32 v[16:17], v[16:17], v[10:11]
  v_cvt_pk_bf16_f32 v244, v16, v17
  v_lshlrev_b32 v10, 16, v245
  v_and_b32 v11, 0xffff0000, v245
  v_pk_add_f32 v[18:19], v[18:19], v[10:11]
  v_cvt_pk_bf16_f32 v245, v18, v19
  v_lshlrev_b32 v10, 16, v246
  v_and_b32 v11, 0xffff0000, v246
  v_pk_add_f32 v[20:21], v[20:21], v[10:11]
  v_cvt_pk_bf16_f32 v246, v20, v21
  v_lshlrev_b32 v10, 16, v247
  v_and_b32 v11, 0xffff0000, v247
  v_pk_add_f32 v[22:23], v[22:23], v[10:11]
  v_cvt_pk_bf16_f32 v247, v22, v23
  v_lshlrev_b32 v10, 16, v248
  v_and_b32 v11, 0xffff0000, v248
  v_pk_add_f32 v[24:25], v[24:25], v[10:11]
  v_cvt_pk_bf16_f32 v248, v24, v25
  v_lshlrev_b32 v10, 16, v249
  v_and_b32 v11, 0xffff0000, v249
  v_pk_add_f32 v[26:27], v[26:27], v[10:11]
  v_cvt_pk_bf16_f32 v249, v26, v27
  v_lshlrev_b32 v10, 16, v250
  v_and_b32 v11, 0xffff0000, v250
  v_pk_add_f32 v[28:29], v[28:29], v[10:11]
  v_cvt_pk_bf16_f32 v250, v28, v29
  v_lshlrev_b32 v10, 16, v251
  v_and_b32 v11, 0xffff0000, v251
  v_pk_add_f32 v[30:31], v[30:31], v[10:11]
  v_cvt_pk_bf16_f32 v251, v30, v31
  v_lshlrev_b32 v10, 16, v252
  v_and_b32 v11, 0xffff0000, v252
  v_pk_add_f32 v[32:33], v[32:33], v[10:11]
  v_cvt_pk_bf16_f32 v252, v32, v33
  v_lshlrev_b32 v10, 16, v253
  v_and_b32 v11, 0xffff0000, v253
  v_pk_add_f32 v[34:35], v[34:35], v[10:11]
  v_cvt_pk_bf16_f32 v253, v34, v35
  s_cmp_eq_u32 s25, 0
  s_cbranch_scc1 Lslow_40
  s_add_u32 s35, s46, 0
  buffer_store_dwordx2 v[244:245], v76, s[20:23], s35 offen
  s_add_u32 s35, s46, 1024
  buffer_store_dwordx2 v[246:247], v76, s[20:23], s35 offen
  s_add_u32 s35, s46, 2048
  buffer_store_dwordx2 v[248:249], v76, s[20:23], s35 offen
  s_add_u32 s35, s46, 3072
  buffer_store_dwordx2 v[250:251], v76, s[20:23], s35 offen
  s_add_u32 s35, s46, 4096
  buffer_store_dwordx2 v[252:253], v76, s[20:23], s35 offen
  s_branch Lend_41
Lslow_40:
  s_add_u32 s35, s46, 0
  buffer_store_dwordx2 v[244:245], v76, s[20:23], s35 offen sc1
  s_add_u32 s35, s46, 1024
  buffer_store_dwordx2 v[246:247], v76, s[20:23], s35 offen sc1
  s_add_u32 s35, s46, 2048
  buffer_store_dwordx2 v[248:249], v76, s[20:23], s35 offen sc1
  s_add_u32 s35, s46, 3072
  buffer_store_dwordx2 v[250:251], v76, s[20:23], s35 offen sc1
  s_add_u32 s35, s46, 4096
  buffer_store_dwordx2 v[252:253], v76, s[20:23], s35 offen sc1
Lend_41:
  v_pk_add_f32 v[10:11], v[16:17], v[18:19]
  v_pk_mul_f32 v[12:13], v[16:17], v[16:17]
  v_pk_fma_f32 v[12:13], v[18:19], v[18:19], v[12:13]
  v_pk_add_f32 v[10:11], v[10:11], v[20:21]
  v_pk_fma_f32 v[12:13], v[20:21], v[20:21], v[12:13]
  v_pk_add_f32 v[10:11], v[10:11], v[22:23]
  v_pk_fma_f32 v[12:13], v[22:23], v[22:23], v[12:13]
  v_pk_add_f32 v[10:11], v[10:11], v[24:25]
  v_pk_fma_f32 v[12:13], v[24:25], v[24:25], v[12:13]
  v_pk_add_f32 v[10:11], v[10:11], v[26:27]
  v_pk_fma_f32 v[12:13], v[26:27], v[26:27], v[12:13]
  v_pk_add_f32 v[10:11], v[10:11], v[28:29]
  v_pk_fma_f32 v[12:13], v[28:29], v[28:29], v[12:13]
  v_pk_add_f32 v[10:11], v[10:11], v[30:31]
  v_pk_fma_f32 v[12:13], v[30:31], v[30:31], v[12:13]
  v_pk_add_f32 v[10:11], v[10:11], v[32:33]
  v_pk_fma_f32 v[12:13], v[32:33], v[32:33], v[12:13]
  v_pk_add_f32 v[10:11], v[10:11], v[34:35]
  v_pk_fma_f32 v[12:13], v[34:35], v[34:35], v[12:13]
  v_add_f32 v10, v10, v11
  v_add_f32 v11, v12, v13
  v_mov_b32 v12, v10
  s_nop 1
  v_permlane32_swap_b32 v10, v12
  v_add_f32 v10, v10, v12
  v_mov_b32 v12, v10
  s_nop 1
  v_permlane16_swap_b32 v10, v12
  v_add_f32 v10, v10, v12
  v_mov_b32 v12, v11
  s_nop 1
  v_permlane32_swap_b32 v11, v12
  v_add_f32 v11, v11, v12
  v_mov_b32 v12, v11
  s_nop 1
  v_permlane16_swap_b32 v11, v12
  v_add_f32 v11, v11, v12
  s_cmp_eq_u32 s25, 0
  s_cbranch_scc1 Lslow_42
  s_mov_b64 exec, 0xffff
  buffer_store_dwordx2 v[10:11], v77, s[20:23], s47 offen
  s_mov_b64 exec, -1
  s_branch Lend_43
Lslow_42:
  s_mov_b64 exec, 0xffff
  buffer_store_dwordx2 v[10:11], v77, s[20:23], s47 offen sc1
  s_mov_b64 exec, -1
Lend_43:
  s_waitcnt vmcnt(0)
  s_barrier
  s_cmp_eq_u32 s3, 0
  s_cbranch_scc0 Lnw1_45
  s_lshl_b32 s38, s4, 11
  s_lshl_b32 s39, s5, 7
  s_add_u32 s39, s39, s38
  s_add_u32 s39, s39, 22085632
  v_mov_b32 v6, s56
  v_mov_b32 v7, s57
  v_mov_b32 v5, 0
  s_mov_b64 exec, 1
  s_cmp_eq_u32 s25, 0
  s_cbranch_scc1 Lslow_46
  buffer_store_dwordx2 v[6:7], v5, s[20:23], s39 offen
  s_branch Lend_47
Lslow_46:
  buffer_store_dwordx2 v[6:7], v5, s[20:23], s39 offen sc1
Lend_47:
  s_mov_b64 exec, -1
Lnw1_45:
  s_cmp_eq_u32 s3, 1
  s_cbranch_scc0 Lnw0_44
  s_lshl_b32 s38, s4, 11
  s_add_u32 s38, s38, 22085632
  v_and_b32 v5, 15, v1
  v_lshlrev_b32 v5, 7, v5
  s_mov_b32 s40, 0
Lpoll_48:
  s_add_u32 s40, s40, 1
  s_cmp_gt_u32 s40, 1048576
  s_cbranch_scc1 Lpollx_49
  buffer_load_dwordx2 v[6:7], v5, s[20:23], s38 offen sc1
  s_waitcnt vmcnt(0)
  v_cmp_eq_u32 vcc, s56, v6
  v_cmp_eq_u32 s[42:43], s57, v7
  s_nop 0
  s_and_b64 vcc, vcc, s[42:43]
  s_cmp_eq_u64 vcc, -1
  s_cbranch_scc0 Lpoll_48
Lpollx_49:
Lnw0_44:
  s_barrier
  v_and_b32 v2, 31, v1
  v_lshrrev_b32 v3, 5, v1
  v_lshlrev_b32 v4, 12, v3
  v_lshl_add_u32 v4, v2, 3, v4
  s_lshl_b32 s34, s4, 13
  s_lshl_b32 s35, s26, 9
  s_add_u32 s34, s34, s35
  s_add_u32 s34, s34, 13631488
  buffer_load_dwordx2 v[160:161], v4, s[20:23], s34 offen offset:0 sc1
  buffer_load_dwordx2 v[162:163], v4, s[20:23], s34 offen offset:1024 sc1
  buffer_load_dwordx2 v[164:165], v4, s[20:23], s34 offen offset:2048 sc1
  buffer_load_dwordx2 v[166:167], v4, s[20:23], s34 offen offset:3072 sc1
  buffer_load_dwordx2 v[168:169], v4, s[20:23], s34 offen offset:256 sc1
  buffer_load_dwordx2 v[170:171], v4, s[20:23], s34 offen offset:1280 sc1
  buffer_load_dwordx2 v[172:173], v4, s[20:23], s34 offen offset:2304 sc1
  buffer_load_dwordx2 v[174:175], v4, s[20:23], s34 offen offset:3328 sc1
  s_lshl_b32 s34, s26, 13
  s_add_u32 s34, s34, 98304
  v_lshl_add_u32 v156, v1, 4, s34
  s_mul_i32 s34, s27, 3072
  v_lshl_add_u32 v157, v1, 4, s34
  v_mov_b32 v153, v157
  v_mov_b32 v152, v156
  v_mov_b32 v16, 0
  v_mov_b32 v17, 0
  v_mov_b32 v18, 0
  v_mov_b32 v19, 0
  v_mov_b32 v20, 0
  v_mov_b32 v21, 0
  v_mov_b32 v22, 0
  v_mov_b32 v23, 0
  v_mov_b32 v24, 0
  v_mov_b32 v25, 0
  v_mov_b32 v26, 0
  v_mov_b32 v27, 0
  v_mov_b32 v28, 0
  v_mov_b32 v29, 0
  v_mov_b32 v30, 0
  v_mov_b32 v31, 0
  v_mov_b32 v32, 0
  v_mov_b32 v33, 0
  v_mov_b32 v34, 0
  v_mov_b32 v35, 0
  v_mov_b32 v36, 0
  v_mov_b32 v37, 0
  v_mov_b32 v38, 0
  v_mov_b32 v39, 0
  v_mov_b32 v40, 0
  v_mov_b32 v41, 0
  v_mov_b32 v42, 0
  v_mov_b32 v43, 0
  v_mov_b32 v44, 0
  v_mov_b32 v45, 0
  v_mov_b32 v46, 0
  v_mov_b32 v47, 0
  v_mov_b32 v48, 0
  v_mov_b32 v49, 0
  v_mov_b32 v50, 0
  v_mov_b32 v51, 0
  v_mov_b32 v52, 0
  v_mov_b32 v53, 0
  v_mov_b32 v54, 0
  v_mov_b32 v55, 0
  v_mov_b32 v56, 0
  v_mov_b32 v57, 0
  v_mov_b32 v58, 0
  v_mov_b32 v59, 0
  v_mov_b32 v60, 0
  v_mov_b32 v61, 0
  v_mov_b32 v62, 0
  v_mov_b32 v63, 0
  v_mov_b32 v64, 0
  v_mov_b32 v65, 0
  v_mov_b32 v66, 0
  v_mov_b32 v67, 0
  v_mov_b32 v68, 0
  v_mov_b32 v69, 0
  v_mov_b32 v70, 0
  v_mov_b32 v71, 0
  v_mov_b32 v72, 0
  v_mov_b32 v73, 0
  v_mov_b32 v74, 0
  v_mov_b32 v75, 0
  v_mov_b32 v76, 0
  v_mov_b32 v77, 0
  v_mov_b32 v78, 0
  v_mov_b32 v79, 0
  v_mov_b32 v80, 0
  v_mov_b32 v81, 0
  v_mov_b32 v82, 0
  v_mov_b32 v83, 0
  v_mov_b32 v84, 0
  v_mov_b32 v85, 0
  v_mov_b32 v86, 0
  v_mov_b32 v87, 0
  v_mov_b32 v88, 0
  v_mov_b32 v89, 0
  v_mov_b32 v90, 0
  v_mov_b32 v91, 0
  v_mov_b32 v92, 0
  v_mov_b32 v93, 0
  v_mov_b32 v94, 0
  v_mov_b32 v95, 0
  v_mov_b32 v96, 0
  v_mov_b32 v97, 0
  v_mov_b32 v98, 0
  v_mov_b32 v99, 0
  v_mov_b32 v100, 0
  v_mov_b32 v101, 0
  v_mov_b32 v102, 0
  v_mov_b32 v103, 0
  v_mov_b32 v104, 0
  v_mov_b32 v105, 0
  v_mov_b32 v106, 0
  v_mov_b32 v107, 0
  v_mov_b32 v108, 0
  v_mov_b32 v109, 0
  v_mov_b32 v110, 0
  v_mov_b32 v111, 0
  s_waitcnt vmcnt(0)
  v_and_b32 v2, 31, v1
  v_lshrrev_b32 v3, 5, v1
  s_mul_i32 s34, s27, 192
  s_add_u32 s34, s34, 161024
  v_lshl_add_u32 v5, v3, 4, s34
  ds_read_b128 v[176:179], v5 offset:0
  ds_read_b128 v[200:203], v5 offset:384
  ds_read_b128 v[180:183], v5 offset:32
  ds_read_b128 v[204:207], v5 offset:416
  ds_read_b128 v[184:187], v5 offset:64
  ds_read_b128 v[208:211], v5 offset:448
  ds_read_b128 v[188:191], v5 offset:96
  ds_read_b128 v[212:215], v5 offset:480
  ds_read_b128 v[192:195], v5 offset:128
  ds_read_b128 v[216:219], v5 offset:512
  ds_read_b128 v[196:199], v5 offset:160
  ds_read_b128 v[220:223], v5 offset:544
  s_mov_b32 s36, 0x3acccccd
  v_pk_add_f32 v[160:161], v[160:161], v[162:163]
  v_pk_add_f32 v[160:161], v[160:161], v[164:165]
  v_pk_add_f32 v[160:161], v[160:161], v[166:167]
  v_mov_b32 v14, v160
  s_nop 1
  v_permlane32_swap_b32 v160, v14
  v_add_f32 v160, v160, v14
  v_mov_b32 v14, v161
  s_nop 1
  v_permlane32_swap_b32 v161, v14
  v_add_f32 v161, v161, v14
  v_mul_f32 v14, s36, v160
  v_mul_f32 v15, s36, v161
  v_fma_f32 v15, -v14, v14, v15
  v_max_f32 v15, 0, v15
  v_add_f32 v15, 0x3727c5ac, v15
  v_rcp_f32 v228, v15
  v_sub_f32 v224, 0, v14
  v_pk_add_f32 v[168:169], v[168:169], v[170:171]
  v_pk_add_f32 v[168:169], v[168:169], v[172:173]
  v_pk_add_f32 v[168:169], v[168:169], v[174:175]
  v_mov_b32 v14, v168
  s_nop 1
  v_permlane32_swap_b32 v168, v14
  v_add_f32 v168, v168, v14
  v_mov_b32 v14, v169
  s_nop 1
  v_permlane32_swap_b32 v169, v14
  v_add_f32 v169, v169, v14
  v_mul_f32 v14, s36, v168
  v_mul_f32 v15, s36, v169
  v_fma_f32 v15, -v14, v14, v15
  v_max_f32 v15, 0, v15
  v_add_f32 v15, 0x3727c5ac, v15
  v_rcp_f32 v230, v15
  v_sub_f32 v226, 0, v14
  s_waitcnt lgkmcnt(0)
  s_barrier
  ds_read_b128 v[112:115], v152 offset:0
  ds_read_b128 v[120:123], v153 offset:0
  ds_read_b128 v[124:127], v153 offset:1024
  ds_read_b128 v[128:131], v153 offset:2048
  ds_read_b128 v[116:119], v152 offset:4096
  s_mov_b32 s32, 0
  s_mov_b32 s33, 0
  s_mov_b32 s34, 0
Lp4_50:
  s_waitcnt lgkmcnt(3)
  v_mfma_f32_32x32x16_bf16 v[16:31], v[120:123], v[112:115], v[16:31]
  ds_read_b128 v[132:135], v152 offset:1024
  s_waitcnt lgkmcnt(3)
  v_mfma_f32_32x32x16_bf16 v[32:47], v[124:127], v[112:115], v[32:47]
  ds_read_b128 v[140:143], v153 offset:6144
  s_waitcnt lgkmcnt(3)
  v_mfma_f32_32x32x16_bf16 v[48:63], v[128:131], v[112:115], v[48:63]
  ds_read_b128 v[144:147], v153 offset:7168
  s_waitcnt lgkmcnt(3)
  v_mfma_f32_32x32x16_bf16 v[64:79], v[120:123], v[116:119], v[64:79]
  ds_read_b128 v[148:151], v153 offset:8192
  v_mfma_f32_32x32x16_bf16 v[80:95], v[124:127], v[116:119], v[80:95]
  ds_read_b128 v[136:139], v152 offset:5120
  v_mfma_f32_32x32x16_bf16 v[96:111], v[128:131], v[116:119], v[96:111]
  s_waitcnt lgkmcnt(3)
  v_mfma_f32_32x32x16_bf16 v[16:31], v[140:143], v[132:135], v[16:31]
  ds_read_b128 v[112:115], v152 offset:2048
  s_waitcnt lgkmcnt(3)
  v_mfma_f32_32x32x16_bf16 v[32:47], v[144:147], v[132:135], v[32:47]
  ds_read_b128 v[120:123], v153 offset:12288
  s_waitcnt lgkmcnt(3)
  v_mfma_f32_32x32x16_bf16 v[48:63], v[148:151], v[132:135], v[48:63]
  ds_read_b128 v[124:127], v153 offset:13312
  s_waitcnt lgkmcnt(3)
  v_mfma_f32_32x32x16_bf16 v[64:79], v[140:143], v[136:139], v[64:79]
  ds_read_b128 v[128:131], v153 offset:14336
  v_mfma_f32_32x32x16_bf16 v[80:95], v[144:147], v[136:139], v[80:95]
  ds_read_b128 v[116:119], v152 offset:6144
  v_mfma_f32_32x32x16_bf16 v[96:111], v[148:151], v[136:139], v[96:111]
  s_waitcnt lgkmcnt(3)
  v_mfma_f32_32x32x16_bf16 v[16:31], v[120:123], v[112:115], v[16:31]
  ds_read_b128 v[132:135], v152 offset:3072
  s_waitcnt lgkmcnt(3)
  v_mfma_f32_32x32x16_bf16 v[32:47], v[124:127], v[112:115], v[32:47]
  ds_read_b128 v[140:143], v153 offset:18432
  s_waitcnt lgkmcnt(3)
  v_mfma_f32_32x32x16_bf16 v[48:63], v[128:131], v[112:115], v[48:63]
  ds_read_b128 v[144:147], v153 offset:19456
  s_waitcnt lgkmcnt(3)
  v_mfma_f32_32x32x16_bf16 v[64:79], v[120:123], v[116:119], v[64:79]
  ds_read_b128 v[148:151], v153 offset:20480
  v_mfma_f32_32x32x16_bf16 v[80:95], v[124:127], v[116:119], v[80:95]
  ds_read_b128 v[136:139], v152 offset:7168
  v_mfma_f32_32x32x16_bf16 v[96:111], v[128:131], v[116:119], v[96:111]
  s_waitcnt lgkmcnt(3)
  v_mfma_f32_32x32x16_bf16 v[16:31], v[140:143], v[132:135], v[16:31]
  s_add_u32 s33, s33, 16384
  s_cmp_eq_u32 s33, 49152
  s_cselect_b32 s33, 0, s33
  s_waitcnt lgkmcnt(2)
  v_mfma_f32_32x32x16_bf16 v[32:47], v[144:147], v[132:135], v[32:47]
  s_add_u32 s34, s34, 24576
  s_cmp_eq_u32 s34, 98304
  s_cselect_b32 s34, 0, s34
  s_waitcnt lgkmcnt(1)
  v_mfma_f32_32x32x16_bf16 v[48:63], v[148:151], v[132:135], v[48:63]
  v_add_u32 v152, s33, v156
  v_add_u32 v153, s34, v157
  s_waitcnt lgkmcnt(0)
  v_mfma_f32_32x32x16_bf16 v[64:79], v[140:143], v[136:139], v[64:79]
  s_barrier
  ds_read_b128 v[112:115], v152 offset:0
  ds_read_b128 v[120:123], v153 offset:0
  ds_read_b128 v[124:127], v153 offset:1024
  v_mfma_f32_32x32x16_bf16 v[80:95], v[144:147], v[136:139], v[80:95]
  ds_read_b128 v[128:131], v153 offset:2048
  ds_read_b128 v[116:119], v152 offset:4096
  v_mfma_f32_32x32x16_bf16 v[96:111], v[148:151], v[136:139], v[96:111]
  s_add_u32 s32, s32, 1
  s_cmp_lt_u32 s32, 10
  s_cbranch_scc1 Lp4_50
  s_waitcnt lgkmcnt(0)
  v_and_b32 v2, 31, v1
  v_lshrrev_b32 v3, 5, v1
  v_lshrrev_b32 v4, 4, v2
  v_mul_u32_u24 v4, 49152, v4
  v_and_b32 v5, 15, v2
  v_lshl_add_u32 v4, v5, 4, v4
  v_lshl_add_u32 v4, v3, 8, v4
  s_lshl_b32 s34, s4, 3
  s_lshl_b32 s35, s26, 2
  s_add_u32 s34, s34, s35
  s_mul_i32 s34, s34, 48
  s_mul_i32 s35, s5, 3
  s_add_u32 s34, s34, s35
  s_lshl_b32 s34, s34, 10
  s_mul_i32 s35, s27, 1536
  s_add_u32 s34, s34, s35
  s_add_u32 s34, s34, 14680064
  v_pk_fma_f32 v[16:17], v[176:177], v[224:225], v[16:17] op_sel_hi:[1,0,1]
  v_pk_fma_f32 v[32:33], v[200:201], v[224:225], v[32:33] op_sel_hi:[1,0,1]
  v_pk_fma_f32 v[18:19], v[178:179], v[224:225], v[18:19] op_sel_hi:[1,0,1]
  v_pk_fma_f32 v[34:35], v[202:203], v[224:225], v[34:35] op_sel_hi:[1,0,1]
  v_max_f32 v16, 0, v16
  v_max_f32 v17, 0, v17
  v_max_f32 v18, 0, v18
  v_max_f32 v19, 0, v19
  v_pk_mul_f32 v[32:33], v[32:33], v[228:229] op_sel_hi:[1,0]
  v_pk_mul_f32 v[34:35], v[34:35], v[228:229] op_sel_hi:[1,0]
  v_pk_mul_f32 v[16:17], v[16:17], v[32:33]
  v_pk_mul_f32 v[18:19], v[18:19], v[34:35]
  v_cvt_pk_bf16_f32 v112, v16, v17
  v_cvt_pk_bf16_f32 v113, v18, v19
  v_pk_fma_f32 v[20:21], v[180:181], v[224:225], v[20:21] op_sel_hi:[1,0,1]
  v_pk_fma_f32 v[36:37], v[204:205], v[224:225], v[36:37] op_sel_hi:[1,0,1]
  v_pk_fma_f32 v[22:23], v[182:183], v[224:225], v[22:23] op_sel_hi:[1,0,1]
  v_pk_fma_f32 v[38:39], v[206:207], v[224:225], v[38:39] op_sel_hi:[1,0,1]
  v_max_f32 v20, 0, v20
  v_max_f32 v21, 0, v21
  v_max_f32 v22, 0, v22
  v_max_f32 v23, 0, v23
  v_pk_mul_f32 v[36:37], v[36:37], v[228:229] op_sel_hi:[1,0]
  v_pk_mul_f32 v[38:39], v[38:39], v[228:229] op_sel_hi:[1,0]
  v_pk_mul_f32 v[20:21], v[20:21], v[36:37]
  v_pk_mul_f32 v[22:23], v[22:23], v[38:39]
  v_cvt_pk_bf16_f32 v114, v20, v21
  v_cvt_pk_bf16_f32 v115, v22, v23
  v_pk_fma_f32 v[24:25], v[184:185], v[224:225], v[24:25] op_sel_hi:[1,0,1]
  v_pk_fma_f32 v[40:41], v[208:209], v[224:225], v[40:41] op_sel_hi:[1,0,1]
  v_pk_fma_f32 v[26:27], v[186:187], v[224:225], v[26:27] op_sel_hi:[1,0,1]
  v_pk_fma_f32 v[42:43], v[210:211], v[224:225], v[42:43] op_sel_hi:[1,0,1]
  v_max_f32 v24, 0, v24
  v_max_f32 v25, 0, v25
  v_max_f32 v26, 0, v26
  v_max_f32 v27, 0, v27
  v_pk_mul_f32 v[40:41], v[40:41], v[228:229] op_sel_hi:[1,0]
  v_pk_mul_f32 v[42:43], v[42:43], v[228:229] op_sel_hi:[1,0]
  v_pk_mul_f32 v[24:25], v[24:25], v[40:41]
  v_pk_mul_f32 v[26:27], v[26:27], v[42:43]
  v_cvt_pk_bf16_f32 v116, v24, v25
  v_cvt_pk_bf16_f32 v117, v26, v27
  v_pk_fma_f32 v[28:29], v[188:189], v[224:225], v[28:29] op_sel_hi:[1,0,1]
  v_pk_fma_f32 v[44:45], v[212:213], v[224:225], v[44:45] op_sel_hi:[1,0,1]
  v_pk_fma_f32 v[30:31], v[190:191], v[224:225], v[30:31] op_sel_hi:[1,0,1]
  v_pk_fma_f32 v[46:47], v[214:215], v[224:225], v[46:47] op_sel_hi:[1,0,1]
  v_max_f32 v28, 0, v28
  v_max_f32 v29, 0, v29
  v_max_f32 v30, 0, v30
  v_max_f32 v31, 0, v31
  v_pk_mul_f32 v[44:45], v[44:45], v[228:229] op_sel_hi:[1,0]
  v_pk_mul_f32 v[46:47], v[46:47], v[228:229] op_sel_hi:[1,0]
  v_pk_mul_f32 v[28:29], v[28:29], v[44:45]
  v_pk_mul_f32 v[30:31], v[30:31], v[46:47]
  v_cvt_pk_bf16_f32 v118, v28, v29
  v_cvt_pk_bf16_f32 v119, v30, v31
  v_pk_fma_f32 v[48:49], v[192:193], v[224:225], v[48:49] op_sel_hi:[1,0,1]
  v_pk_fma_f32 v[56:57], v[216:217], v[224:225], v[56:57] op_sel_hi:[1,0,1]
  v_pk_fma_f32 v[50:51], v[194:195], v[224:225], v[50:51] op_sel_hi:[1,0,1]
  v_pk_fma_f32 v[58:59], v[218:219], v[224:225], v[58:59] op_sel_hi:[1,0,1]
  v_max_f32 v48, 0, v48
  v_max_f32 v49, 0, v49
  v_max_f32 v50, 0, v50
  v_max_f32 v51, 0, v51
  v_pk_mul_f32 v[56:57], v[56:57], v[228:229] op_sel_hi:[1,0]
  v_pk_mul_f32 v[58:59], v[58:59], v[228:229] op_sel_hi:[1,0]
  v_pk_mul_f32 v[48:49], v[48:49], v[56:57]
  v_pk_mul_f32 v[50:51], v[50:51], v[58:59]
  v_cvt_pk_bf16_f32 v120, v48, v49
  v_cvt_pk_bf16_f32 v121, v50, v51
  v_pk_fma_f32 v[52:53], v[196:197], v[224:225], v[52:53] op_sel_hi:[1,0,1]
  v_pk_fma_f32 v[60:61], v[220:221], v[224:225], v[60:61] op_sel_hi:[1,0,1]
  v_pk_fma_f32 v[54:55], v[198:199], v[224:225], v[54:55] op_sel_hi:[1,0,1]
  v_pk_fma_f32 v[62:63], v[222:223], v[224:225], v[62:63] op_sel_hi:[1,0,1]
  v_max_f32 v52, 0, v52
  v_max_f32 v53, 0, v53
  v_max_f32 v54, 0, v54
  v_max_f32 v55, 0, v55
  v_pk_mul_f32 v[60:61], v[60:61], v[228:229] op_sel_hi:[1,0]
  v_pk_mul_f32 v[62:63], v[62:63], v[228:229] op_sel_hi:[1,0]
  v_pk_mul_f32 v[52:53], v[52:53], v[60:61]
  v_pk_mul_f32 v[54:55], v[54:55], v[62:63]
  v_cvt_pk_bf16_f32 v122, v52, v53
  v_cvt_pk_bf16_f32 v123, v54, v55
  v_pk_fma_f32 v[64:65], v[176:177], v[226:227], v[64:65] op_sel_hi:[1,0,1]
  v_pk_fma_f32 v[80:81], v[200:201], v[226:227], v[80:81] op_sel_hi:[1,0,1]
  v_pk_fma_f32 v[66:67], v[178:179], v[226:227], v[66:67] op_sel_hi:[1,0,1]
  v_pk_fma_f32 v[82:83], v[202:203], v[226:227], v[82:83] op_sel_hi:[1,0,1]
  v_max_f32 v64, 0, v64
  v_max_f32 v65, 0, v65
  v_max_f32 v66, 0, v66
  v_max_f32 v67, 0, v67
  v_pk_mul_f32 v[80:81], v[80:81], v[230:231] op_sel_hi:[1,0]
  v_pk_mul_f32 v[82:83], v[82:83], v[230:231] op_sel_hi:[1,0]
  v_pk_mul_f32 v[64:65], v[64:65], v[80:81]
  v_pk_mul_f32 v[66:67], v[66:67], v[82:83]
  v_cvt_pk_bf16_f32 v124, v64, v65
  v_cvt_pk_bf16_f32 v125, v66, v67
  v_pk_fma_f32 v[68:69], v[180:181], v[226:227], v[68:69] op_sel_hi:[1,0,1]
  v_pk_fma_f32 v[84:85], v[204:205], v[226:227], v[84:85] op_sel_hi:[1,0,1]
  v_pk_fma_f32 v[70:71], v[182:183], v[226:227], v[70:71] op_sel_hi:[1,0,1]
  v_pk_fma_f32 v[86:87], v[206:207], v[226:227], v[86:87] op_sel_hi:[1,0,1]
  v_max_f32 v68, 0, v68
  v_max_f32 v69, 0, v69
  v_max_f32 v70, 0, v70
  v_max_f32 v71, 0, v71
  v_pk_mul_f32 v[84:85], v[84:85], v[230:231] op_sel_hi:[1,0]
  v_pk_mul_f32 v[86:87], v[86:87], v[230:231] op_sel_hi:[1,0]
  v_pk_mul_f32 v[68:69], v[68:69], v[84:85]
  v_pk_mul_f32 v[70:71], v[70:71], v[86:87]
  v_cvt_pk_bf16_f32 v126, v68, v69
  v_cvt_pk_bf16_f32 v127, v70, v71
  v_pk_fma_f32 v[72:73], v[184:185], v[226:227], v[72:73] op_sel_hi:[1,0,1]
  v_pk_fma_f32 v[88:89], v[208:209], v[226:227], v[88:89] op_sel_hi:[1,0,1]
  v_pk_fma_f32 v[74:75], v[186:187], v[226:227], v[74:75] op_sel_hi:[1,0,1]
  v_pk_fma_f32 v[90:91], v[210:211], v[226:227], v[90:91] op_sel_hi:[1,0,1]
  v_max_f32 v72, 0, v72
  v_max_f32 v73, 0, v73
  v_max_f32 v74, 0, v74
  v_max_f32 v75, 0, v75
  v_pk_mul_f32 v[88:89], v[88:89], v[230:231] op_sel_hi:[1,0]
  v_pk_mul_f32 v[90:91], v[90:91], v[230:231] op_sel_hi:[1,0]
  v_pk_mul_f32 v[72:73], v[72:73], v[88:89]
  v_pk_mul_f32 v[74:75], v[74:75], v[90:91]
  v_cvt_pk_bf16_f32 v128, v72, v73
  v_cvt_pk_bf16_f32 v129, v74, v75
  v_pk_fma_f32 v[76:77], v[188:189], v[226:227], v[76:77] op_sel_hi:[1,0,1]
  v_pk_fma_f32 v[92:93], v[212:213], v[226:227], v[92:93] op_sel_hi:[1,0,1]
  v_pk_fma_f32 v[78:79], v[190:191], v[226:227], v[78:79] op_sel_hi:[1,0,1]
  v_pk_fma_f32 v[94:95], v[214:215], v[226:227], v[94:95] op_sel_hi:[1,0,1]
  v_max_f32 v76, 0, v76
  v_max_f32 v77, 0, v77
  v_max_f32 v78, 0, v78
  v_max_f32 v79, 0, v79
  v_pk_mul_f32 v[92:93], v[92:93], v[230:231] op_sel_hi:[1,0]
  v_pk_mul_f32 v[94:95], v[94:95], v[230:231] op_sel_hi:[1,0]
  v_pk_mul_f32 v[76:77], v[76:77], v[92:93]
  v_pk_mul_f32 v[78:79], v[78:79], v[94:95]
  v_cvt_pk_bf16_f32 v130, v76, v77
  v_cvt_pk_bf16_f32 v131, v78, v79
  v_pk_fma_f32 v[96:97], v[192:193], v[226:227], v[96:97] op_sel_hi:[1,0,1]
  v_pk_fma_f32 v[104:105], v[216:217], v[226:227], v[104:105] op_sel_hi:[1,0,1]
  v_pk_fma_f32 v[98:99], v[194:195], v[226:227], v[98:99] op_sel_hi:[1,0,1]
  v_pk_fma_f32 v[106:107], v[218:219], v[226:227], v[106:107] op_sel_hi:[1,0,1]
  v_max_f32 v96, 0, v96
  v_max_f32 v97, 0, v97
  v_max_f32 v98, 0, v98
  v_max_f32 v99, 0, v99
  v_pk_mul_f32 v[104:105], v[104:105], v[230:231] op_sel_hi:[1,0]
  v_pk_mul_f32 v[106:107], v[106:107], v[230:231] op_sel_hi:[1,0]
  v_pk_mul_f32 v[96:97], v[96:97], v[104:105]
  v_pk_mul_f32 v[98:99], v[98:99], v[106:107]
  v_cvt_pk_bf16_f32 v132, v96, v97
  v_cvt_pk_bf16_f32 v133, v98, v99
  v_pk_fma_f32 v[100:101], v[196:197], v[226:227], v[100:101] op_sel_hi:[1,0,1]
  v_pk_fma_f32 v[108:109], v[220:221], v[226:227], v[108:109] op_sel_hi:[1,0,1]
  v_pk_fma_f32 v[102:103], v[198:199], v[226:227], v[102:103] op_sel_hi:[1,0,1]
  v_pk_fma_f32 v[110:111], v[222:223], v[226:227], v[110:111] op_sel_hi:[1,0,1]
  v_max_f32 v100, 0, v100
  v_max_f32 v101, 0, v101
  v_max_f32 v102, 0, v102
  v_max_f32 v103, 0, v103
  v_pk_mul_f32 v[108:109], v[108:109], v[230:231] op_sel_hi:[1,0]
  v_pk_mul_f32 v[110:111], v[110:111], v[230:231] op_sel_hi:[1,0]
  v_pk_mul_f32 v[100:101], v[100:101], v[108:109]
  v_pk_mul_f32 v[102:103], v[102:103], v[110:111]
  v_cvt_pk_bf16_f32 v134, v100, v101
  v_cvt_pk_bf16_f32 v135, v102, v103
  s_cmp_eq_u32 s25, 0
  s_cbranch_scc1 Lslow_51
  s_add_u32 s35, s34, 0
  buffer_store_dwordx4 v[112:115], v4, s[20:23], s35 offen
  s_add_u32 s35, s34, 512
  buffer_store_dwordx4 v[116:119], v4, s[20:23], s35 offen
  s_add_u32 s35, s34, 1024
  buffer_store_dwordx4 v[120:123], v4, s[20:23], s35 offen
  s_add_u32 s35, s34, 98304
  buffer_store_dwordx4 v[124:127], v4, s[20:23], s35 offen
  s_add_u32 s35, s34, 98816
  buffer_store_dwordx4 v[128:131], v4, s[20:23], s35 offen
  s_add_u32 s35, s34, 99328
  buffer_store_dwordx4 v[132:135], v4, s[20:23], s35 offen
  s_branch Lend_52
Lslow_51:
  s_add_u32 s35, s34, 0
  buffer_store_dwordx4 v[112:115], v4, s[20:23], s35 offen sc1
  s_add_u32 s35, s34, 512
  buffer_store_dwordx4 v[116:119], v4, s[20:23], s35 offen sc1
  s_add_u32 s35, s34, 1024
  buffer_store_dwordx4 v[120:123], v4, s[20:23], s35 offen sc1
  s_add_u32 s35, s34, 98304
  buffer_store_dwordx4 v[124:127], v4, s[20:23], s35 offen sc1
  s_add_u32 s35, s34, 98816
  buffer_store_dwordx4 v[128:131], v4, s[20:23], s35 offen sc1
  s_add_u32 s35, s34, 99328
  buffer_store_dwordx4 v[132:135], v4, s[20:23], s35 offen sc1
Lend_52:
  s_waitcnt vmcnt(0)
  s_barrier
  s_cmp_eq_u32 s3, 0
  s_cbranch_scc0 Lnw1_54
  s_lshl_b32 s38, s4, 11
  s_lshl_b32 s39, s5, 7
  s_add_u32 s39, s39, s38
  s_add_u32 s39, s39, 22118400
  v_mov_b32 v6, s56
  v_mov_b32 v7, s57
  v_mov_b32 v5, 0
  s_mov_b64 exec, 1
  s_cmp_eq_u32 s25, 0
  s_cbranch_scc1 Lslow_55
  buffer_store_dwordx2 v[6:7], v5, s[20:23], s39 offen
  s_branch Lend_56
Lslow_55:
  buffer_store_dwordx2 v[6:7], v5, s[20:23], s39 offen sc1
Lend_56:
  s_mov_b64 exec, -1
Lnw1_54:
  s_cmp_eq_u32 s3, 1
  s_cbranch_scc0 Lnw0_53
  s_lshl_b32 s38, s4, 11
  s_add_u32 s38, s38, 22118400
  v_and_b32 v5, 15, v1
  v_lshlrev_b32 v5, 7, v5
  s_mov_b32 s40, 0
Lpoll_57:
  s_add_u32 s40, s40, 1
  s_cmp_gt_u32 s40, 1048576
  s_cbranch_scc1 Lpollx_58
  buffer_load_dwordx2 v[6:7], v5, s[20:23], s38 offen sc1
  s_waitcnt vmcnt(0)
  v_cmp_eq_u32 vcc, s56, v6
  v_cmp_eq_u32 s[42:43], s57, v7
  s_nop 0
  s_and_b64 vcc, vcc, s[42:43]
  s_cmp_eq_u64 vcc, -1
  s_cbranch_scc0 Lpoll_57
Lpollx_58:
Lnw0_53:
  s_barrier
  v_lshrrev_b32 v4, 4, v1
  v_lshlrev_b32 v91, 4, v1
  s_lshl_b32 s34, s3, 12
  s_add_u32 s34, s34, 102400
  v_lshl_add_u32 v90, v1, 4, s34
  v_mov_b32 v89, v91
  v_mov_b32 v88, v90
  v_mov_b32 v16, 0
  v_mov_b32 v17, 0
  v_mov_b32 v18, 0
  v_mov_b32 v19, 0
  v_mov_b32 v20, 0
  v_mov_b32 v21, 0
  v_mov_b32 v22, 0
  v_mov_b32 v23, 0
  v_mov_b32 v24, 0
  v_mov_b32 v25, 0
  v_mov_b32 v26, 0
  v_mov_b32 v27, 0
  v_mov_b32 v28, 0
  v_mov_b32 v29, 0
  v_mov_b32 v30, 0
  v_mov_b32 v31, 0
  v_mov_b32 v32, 0
  v_mov_b32 v33, 0
  v_mov_b32 v34, 0
  v_mov_b32 v35, 0
  s_barrier
  ds_read_b128 v[40:43], v88 offset:0
  ds_read_b128 v[44:47], v89 offset:0
  ds_read_b128 v[48:51], v89 offset:1024
  ds_read_b128 v[52:55], v89 offset:2048
  ds_read_b128 v[56:59], v89 offset:3072
  ds_read_b128 v[60:63], v89 offset:4096
  s_mov_b32 s32, 0
  s_mov_b32 s33, 0
  s_mov_b32 s34, 0
Lp5_59:
  s_waitcnt lgkmcnt(4)
  v_mfma_f32_16x16x32_bf16 v[16:19], v[44:47], v[40:43], v[16:19]
  ds_read_b128 v[64:67], v88 offset:1024
  s_waitcnt lgkmcnt(4)
  v_mfma_f32_16x16x32_bf16 v[20:23], v[48:51], v[40:43], v[20:23]
  ds_read_b128 v[68:71], v89 offset:5120
  s_waitcnt lgkmcnt(4)
  v_mfma_f32_16x16x32_bf16 v[24:27], v[52:55], v[40:43], v[24:27]
  ds_read_b128 v[72:75], v89 offset:6144
  s_waitcnt lgkmcnt(4)
  v_mfma_f32_16x16x32_bf16 v[28:31], v[56:59], v[40:43], v[28:31]
  ds_read_b128 v[76:79], v89 offset:7168
  s_waitcnt lgkmcnt(4)
  v_mfma_f32_16x16x32_bf16 v[32:35], v[60:63], v[40:43], v[32:35]
  ds_read_b128 v[80:83], v89 offset:8192
  ds_read_b128 v[84:87], v89 offset:9216
  s_waitcnt lgkmcnt(4)
  v_mfma_f32_16x16x32_bf16 v[16:19], v[68:71], v[64:67], v[16:19]
  ds_read_b128 v[40:43], v88 offset:2048
  s_waitcnt lgkmcnt(4)
  v_mfma_f32_16x16x32_bf16 v[20:23], v[72:75], v[64:67], v[20:23]
  ds_read_b128 v[44:47], v89 offset:10240
  s_waitcnt lgkmcnt(4)
  v_mfma_f32_16x16x32_bf16 v[24:27], v[76:79], v[64:67], v[24:27]
  ds_read_b128 v[48:51], v89 offset:11264
  s_waitcnt lgkmcnt(4)
  v_mfma_f32_16x16x32_bf16 v[28:31], v[80:83], v[64:67], v[28:31]
  ds_read_b128 v[52:55], v89 offset:12288
  s_waitcnt lgkmcnt(4)
  v_mfma_f32_16x16x32_bf16 v[32:35], v[84:87], v[64:67], v[32:35]
  ds_read_b128 v[56:59], v89 offset:13312
  ds_read_b128 v[60:63], v89 offset:14336
  s_waitcnt lgkmcnt(4)
  v_mfma_f32_16x16x32_bf16 v[16:19], v[44:47], v[40:43], v[16:19]
  ds_read_b128 v[64:67], v88 offset:3072
  s_waitcnt lgkmcnt(4)
  v_mfma_f32_16x16x32_bf16 v[20:23], v[48:51], v[40:43], v[20:23]
  ds_read_b128 v[68:71], v89 offset:15360
  s_waitcnt lgkmcnt(4)
  v_mfma_f32_16x16x32_bf16 v[24:27], v[52:55], v[40:43], v[24:27]
  ds_read_b128 v[72:75], v89 offset:16384
  s_waitcnt lgkmcnt(4)
  v_mfma_f32_16x16x32_bf16 v[28:31], v[56:59], v[40:43], v[28:31]
  ds_read_b128 v[76:79], v89 offset:17408
  s_waitcnt lgkmcnt(4)
  v_mfma_f32_16x16x32_bf16 v[32:35], v[60:63], v[40:43], v[32:35]
  ds_read_b128 v[80:83], v89 offset:18432
  ds_read_b128 v[84:87], v89 offset:19456
  s_waitcnt lgkmcnt(4)
  v_mfma_f32_16x16x32_bf16 v[16:19], v[68:71], v[64:67], v[16:19]
  s_add_u32 s33, s33, 16384
  s_cmp_eq_u32 s33, 49152
  s_cselect_b32 s33, 0, s33
  s_waitcnt lgkmcnt(3)
  v_mfma_f32_16x16x32_bf16 v[20:23], v[72:75], v[64:67], v[20:23]
  s_add_u32 s34, s34, 20480
  s_cmp_eq_u32 s34, 102400
  s_cselect_b32 s34, 0, s34
  s_waitcnt lgkmcnt(2)
  v_mfma_f32_16x16x32_bf16 v[24:27], v[76:79], v[64:67], v[24:27]
  v_add_u32 v88, s33, v90
  v_add_u32 v89, s34, v91
  s_waitcnt lgkmcnt(0)
  s_barrier
  ds_read_b128 v[40:43], v88 offset:0
  ds_read_b128 v[44:47], v89 offset:0
  ds_read_b128 v[48:51], v89 offset:1024
  v_mfma_f32_16x16x32_bf16 v[28:31], v[80:83], v[64:67], v[28:31]
  ds_read_b128 v[52:55], v89 offset:2048
  ds_read_b128 v[56:59], v89 offset:3072
  ds_read_b128 v[60:63], v89 offset:4096
  v_mfma_f32_16x16x32_bf16 v[32:35], v[84:87], v[64:67], v[32:35]
  s_add_u32 s32, s32, 1
  s_cmp_lt_u32 s32, 12
  s_cbranch_scc1 Lp5_59
  s_waitcnt lgkmcnt(0)
  v_and_b32 v2, 15, v1
  v_lshlrev_b32 v10, 16, v244
  v_and_b32 v11, 0xffff0000, v244
  v_pk_add_f32 v[16:17], v[16:17], v[10:11]
  v_cvt_pk_bf16_f32 v100, v16, v17
  v_lshlrev_b32 v10, 16, v245
  v_and_b32 v11, 0xffff0000, v245
  v_pk_add_f32 v[18:19], v[18:19], v[10:11]
  v_cvt_pk_bf16_f32 v101, v18, v19
  v_lshlrev_b32 v10, 16, v246
  v_and_b32 v11, 0xffff0000, v246
  v_pk_add_f32 v[20:21], v[20:21], v[10:11]
  v_cvt_pk_bf16_f32 v102, v20, v21
  v_lshlrev_b32 v10, 16, v247
  v_and_b32 v11, 0xffff0000, v247
  v_pk_add_f32 v[22:23], v[22:23], v[10:11]
  v_cvt_pk_bf16_f32 v103, v22, v23
  v_lshlrev_b32 v10, 16, v248
  v_and_b32 v11, 0xffff0000, v248
  v_pk_add_f32 v[24:25], v[24:25], v[10:11]
  v_cvt_pk_bf16_f32 v104, v24, v25
  v_lshlrev_b32 v10, 16, v249
  v_and_b32 v11, 0xffff0000, v249
  v_pk_add_f32 v[26:27], v[26:27], v[10:11]
  v_cvt_pk_bf16_f32 v105, v26, v27
  v_lshlrev_b32 v10, 16, v250
  v_and_b32 v11, 0xffff0000, v250
  v_pk_add_f32 v[28:29], v[28:29], v[10:11]
  v_cvt_pk_bf16_f32 v106, v28, v29
  v_lshlrev_b32 v10, 16, v251
  v_and_b32 v11, 0xffff0000, v251
  v_pk_add_f32 v[30:31], v[30:31], v[10:11]
  v_cvt_pk_bf16_f32 v107, v30, v31
  v_lshlrev_b32 v10, 16, v252
  v_and_b32 v11, 0xffff0000, v252
  v_pk_add_f32 v[32:33], v[32:33], v[10:11]
  v_cvt_pk_bf16_f32 v108, v32, v33
  v_lshlrev_b32 v10, 16, v253
  v_and_b32 v11, 0xffff0000, v253
  v_pk_add_f32 v[34:35], v[34:35], v[10:11]
  v_cvt_pk_bf16_f32 v109, v34, v35
  s_lshl_b32 s34, s3, 4
  v_add_u32 v5, s34, v2
  v_mul_u32_u24 v5, 160, v5
  v_lshl_add_u32 v5, v4, 3, v5
  v_add_u32 v5, 153600, v5
  ds_write_b64 v5, v[100:101] offset:0
  ds_write_b64 v5, v[102:103] offset:32
  ds_write_b64 v5, v[104:105] offset:64
  ds_write_b64 v5, v[106:107] offset:96
  ds_write_b64 v5, v[108:109] offset:128
  s_waitcnt lgkmcnt(0)
  s_branch sequential_preLN__linear_kernel_hedgehog__glu_gated_reglu__prompt_kernel_fin
sequential_preLN__linear_kernel_hedgehog__glu_gated_reglu__prompt_kernel_loader:
  s_sub_u32 s26, s3, 4
  v_lshrrev_b32 v2, 3, v1
  v_and_b32 v3, 7, v1
  v_lshrrev_b32 v4, 4, v1
  s_and_b32 s33, s26, 1
  s_lshl_b32 s33, s33, 2
  v_add_u32 v4, s33, v4
  v_xor_b32 v3, v3, v4
  v_mul_u32_u24 v10, 1280, v2
  v_lshl_add_u32 v10, v3, 4, v10
  v_lshrrev_b32 v2, 4, v1
  v_and_b32 v3, 15, v1
  v_lshlrev_b32 v4, 2, v2
  v_xor_b32 v3, v3, v4
  v_and_b32 v4, 7, v3
  v_lshlrev_b32 v4, 2, v4
  v_cmp_le_u32 vcc, 8, v3
  v_mov_b32 v5, 0x10323210
  v_mov_b32 v6, 0x44441302
  v_cndmask_b32 v5, v5, v6, vcc
  v_bfe_u32 v5, v5, v4, 4
  v_mov_b32 v6, 0x11110000
  v_mov_b32 v7, 0x11202222
  v_cndmask_b32 v6, v6, v7, vcc
  v_bfe_u32 v6, v6, v4, 4
  s_mul_i32 s34, s6, 80
  s_mul_i32 s35, s5, 80
  v_mov_b32 v7, s35
  v_mov_b32 v8, s34
  v_cmp_eq_u32 vcc, 0, v6
  s_nop 1
  v_cndmask_b32 v7, v7, v8, vcc
  v_mul_u32_u24 v11, 1280, v6
  v_add_u32 v11, v11, v7
  v_lshl_add_u32 v11, v5, 4, v11
  v_mul_u32_u24 v2, 3840, v2
  v_add_u32 v11, v11, v2
  s_lshl_b32 s36, s4, 7
  s_lshl_b32 s37, s26, 3
  s_add_u32 s36, s36, s37
  s_mul_i32 s36, s36, 1280
  s_mul_i32 s37, s26, 15360
  s_lshl_b32 s38, s26, 10
  v_lshlrev_b32 v12, 4, v1
  s_lshr_b32 s39, s26, 1
  s_cmp_eq_u32 s39, 0
  s_cselect_b32 s40, s6, s5
  s_mul_i32 s40, s40, 1600
  s_and_b32 s41, s26, 1
  s_lshl_b32 s41, s41, 10
  s_add_u32 s40, s40, s41
  s_and_b32 s43, s2, 7
  s_mul_i32 s43, s43, 5
  s_lshr_b32 s43, s43, 2
  s_add_u32 s44, s43, 0
  s_cmp_ge_u32 s44, 10
  s_cselect_b32 s45, 10, 0
  s_sub_u32 s44, s44, s45
  s_lshl_b32 s45, s44, 7
  s_add_u32 s45, s45, s36
  s_mul_i32 s44, s44, 245760
  s_add_u32 s44, s44, s37
  s_add_u32 s42, s45, 0
  s_add_u32 m0, s38, 0
  s_nop 0
  buffer_load_dwordx4 v10, s[8:11], s42 offen lds
  s_add_u32 s42, s44, 0
  s_add_u32 m0, s38, 65536
  s_nop 0
  buffer_load_dwordx4 v11, s[12:15], s42 offen lds
  s_add_u32 s42, s45, 40960
  s_add_u32 m0, s38, 4096
  s_nop 0
  buffer_load_dwordx4 v10, s[8:11], s42 offen lds
  s_add_u32 s42, s44, 61440
  s_add_u32 m0, s38, 69632
  s_nop 0
  buffer_load_dwordx4 v11, s[12:15], s42 offen lds
  s_add_u32 s42, s45, 81920
  s_add_u32 m0, s38, 8192
  s_nop 0
  buffer_load_dwordx4 v10, s[8:11], s42 offen lds
  s_add_u32 s42, s44, 122880
  s_add_u32 m0, s38, 73728
  s_nop 0
  buffer_load_dwordx4 v11, s[12:15], s42 offen lds
  s_add_u32 s42, s45, 122880
  s_add_u32 m0, s38, 12288
  s_nop 0
  buffer_load_dwordx4 v10, s[8:11], s42 offen lds
  s_add_u32 s42, s44, 184320
  s_add_u32 m0, s38, 77824
  s_nop 0
  buffer_load_dwordx4 v11, s[12:15], s42 offen lds
  s_barrier
  s_add_u32 s44, s43, 1
  s_cmp_ge_u32 s44, 10
  s_cselect_b32 s45, 10, 0
  s_sub_u32 s44, s44, s45
  s_lshl_b32 s45, s44, 7
  s_add_u32 s45, s45, s36
  s_mul_i32 s44, s44, 245760
  s_add_u32 s44, s44, s37
  s_add_u32 s42, s45, 0
  s_add_u32 m0, s38, 16384
  s_nop 0
  buffer_load_dwordx4 v10, s[8:11], s42 offen lds
  s_add_u32 s42, s44, 0
  s_add_u32 m0, s38, 81920
  s_nop 0
  buffer_load_dwordx4 v11, s[12:15], s42 offen lds
  s_add_u32 s42, s45, 40960
  s_add_u32 m0, s38, 20480
  s_nop 0
  buffer_load_dwordx4 v10, s[8:11], s42 offen lds
  s_add_u32 s42, s44, 61440
  s_add_u32 m0, s38, 86016
  s_nop 0
  buffer_load_dwordx4 v11, s[12:15], s42 offen lds
  s_add_u32 s42, s45, 81920
  s_add_u32 m0, s38, 24576
  s_nop 0
  buffer_load_dwordx4 v10, s[8:11], s42 offen lds
  s_add_u32 s42, s44, 122880
  s_add_u32 m0, s38, 90112
  s_nop 0
  buffer_load_dwordx4 v11, s[12:15], s42 offen lds
  s_add_u32 s42, s45, 122880
  s_add_u32 m0, s38, 28672
  s_nop 0
  buffer_load_dwordx4 v10, s[8:11], s42 offen lds
  s_add_u32 s42, s44, 184320
  s_add_u32 m0, s38, 94208
  s_nop 0
  buffer_load_dwordx4 v11, s[12:15], s42 offen lds
  s_waitcnt vmcnt(8)
  s_barrier
  s_add_u32 s44, s43, 2
  s_cmp_ge_u32 s44, 10
  s_cselect_b32 s45, 10, 0
  s_sub_u32 s44, s44, s45
  s_lshl_b32 s45, s44, 7
  s_add_u32 s45, s45, s36
  s_mul_i32 s44, s44, 245760
  s_add_u32 s44, s44, s37
  s_add_u32 s42, s45, 0
  s_add_u32 m0, s38, 32768
  s_nop 0
  buffer_load_dwordx4 v10, s[8:11], s42 offen lds
  s_add_u32 s42, s44, 0
  s_add_u32 m0, s38, 98304
  s_nop 0
  buffer_load_dwordx4 v11, s[12:15], s42 offen lds
  s_add_u32 s42, s45, 40960
  s_add_u32 m0, s38, 36864
  s_nop 0
  buffer_load_dwordx4 v10, s[8:11], s42 offen lds
  s_add_u32 s42, s44, 61440
  s_add_u32 m0, s38, 102400
  s_nop 0
  buffer_load_dwordx4 v11, s[12:15], s42 offen lds
  s_add_u32 s42, s45, 81920
  s_add_u32 m0, s38, 40960
  s_nop 0
  buffer_load_dwordx4 v10, s[8:11], s42 offen lds
  s_add_u32 s42, s44, 122880
  s_add_u32 m0, s38, 106496
  s_nop 0
  buffer_load_dwordx4 v11, s[12:15], s42 offen lds
  s_add_u32 s42, s45, 122880
  s_add_u32 m0, s38, 45056
  s_nop 0
  buffer_load_dwordx4 v10, s[8:11], s42 offen lds
  s_add_u32 s42, s44, 184320
  s_add_u32 m0, s38, 110592
  s_nop 0
  buffer_load_dwordx4 v11, s[12:15], s42 offen lds
  s_add_u32 m0, s38, 153600
  s_nop 0
  buffer_load_dwordx4 v12, s[16:19], s40 offen lds
  s_cmp_eq_u32 s26, 3
  s_cbranch_scc0 Lnocpf_60
  s_getpc_b64 s[50:51]
sequential_preLN__linear_kernel_hedgehog__glu_gated_reglu__prompt_kernel_pc:
  s_sub_u32 s50, s50, sequential_preLN__linear_kernel_hedgehog__glu_gated_reglu__prompt_kernel_pc-sequential_preLN__linear_kernel_hedgehog__glu_gated_reglu__prompt_kernel
  s_subb_u32 s51, s51, 0
  s_bfe_u32 s48, s2, 0x20003
  s_lshl_b32 s48, s48, 13
  v_lshlrev_b32 v2, 7, v1
  v_add_u32 v2, s48, v2
  s_mov_b32 s49, L_text_end-sequential_preLN__linear_kernel_hedgehog__glu_gated_reglu__prompt_kernel
  v_cmp_gt_u32 vcc, s49, v2
  s_nop 0
  s_and_saveexec_b64 s[46:47], vcc
  s_cbranch_execz Lcq_62
  global_load_dword v21, v2, s[50:51]
Lcq_62:
  s_mov_b64 exec, s[46:47]
  v_add_u32 v2, 0x8000, v2
  v_cmp_gt_u32 vcc, s49, v2
  s_nop 0
  s_and_saveexec_b64 s[46:47], vcc
  s_cbranch_execz Lcq_63
  global_load_dword v21, v2, s[50:51]
Lcq_63:
  s_mov_b64 exec, s[46:47]
  v_add_u32 v2, 0x8000, v2
Lnocpf_60:
  s_waitcnt vmcnt(8)
  s_barrier
  s_add_u32 s44, s43, 3
  s_cmp_ge_u32 s44, 10
  s_cselect_b32 s45, 10, 0
  s_sub_u32 s44, s44, s45
  s_lshl_b32 s45, s44, 7
  s_add_u32 s45, s45, s36
  s_mul_i32 s44, s44, 245760
  s_add_u32 s44, s44, s37
  s_add_u32 s42, s45, 0
  s_add_u32 m0, s38, 49152
  s_nop 0
  buffer_load_dwordx4 v10, s[8:11], s42 offen lds
  s_add_u32 s42, s44, 0
  s_add_u32 m0, s38, 114688
  s_nop 0
  buffer_load_dwordx4 v11, s[12:15], s42 offen lds
  s_add_u32 s42, s45, 40960
  s_add_u32 m0, s38, 53248
  s_nop 0
  buffer_load_dwordx4 v10, s[8:11], s42 offen lds
  s_add_u32 s42, s44, 61440
  s_add_u32 m0, s38, 118784
  s_nop 0
  buffer_load_dwordx4 v11, s[12:15], s42 offen lds
  s_add_u32 s42, s45, 81920
  s_add_u32 m0, s38, 57344
  s_nop 0
  buffer_load_dwordx4 v10, s[8:11], s42 offen lds
  s_add_u32 s42, s44, 122880
  s_add_u32 m0, s38, 122880
  s_nop 0
  buffer_load_dwordx4 v11, s[12:15], s42 offen lds
  s_add_u32 s42, s45, 122880
  s_add_u32 m0, s38, 61440
  s_nop 0
  buffer_load_dwordx4 v10, s[8:11], s42 offen lds
  s_add_u32 s42, s44, 184320
  s_add_u32 m0, s38, 126976
  s_nop 0
  buffer_load_dwordx4 v11, s[12:15], s42 offen lds
  s_waitcnt vmcnt(8)
  s_barrier
  s_add_u32 s44, s43, 4
  s_cmp_ge_u32 s44, 10
  s_cselect_b32 s45, 10, 0
  s_sub_u32 s44, s44, s45
  s_lshl_b32 s45, s44, 7
  s_add_u32 s45, s45, s36
  s_mul_i32 s44, s44, 245760
  s_add_u32 s44, s44, s37
  s_add_u32 s42, s45, 0
  s_add_u32 m0, s38, 0
  s_nop 0
  buffer_load_dwordx4 v10, s[8:11], s42 offen lds
  s_add_u32 s42, s44, 0
  s_add_u32 m0, s38, 65536
  s_nop 0
  buffer_load_dwordx4 v11, s[12:15], s42 offen lds
  s_add_u32 s42, s45, 40960
  s_add_u32 m0, s38, 4096
  s_nop 0
  buffer_load_dwordx4 v10, s[8:11], s42 offen lds
  s_add_u32 s42, s44, 61440
  s_add_u32 m0, s38, 69632
  s_nop 0
  buffer_load_dwordx4 v11, s[12:15], s42 offen lds
  s_add_u32 s42, s45, 81920
  s_add_u32 m0, s38, 8192
  s_nop 0
  buffer_load_dwordx4 v10, s[8:11], s42 offen lds
  s_add_u32 s42, s44, 122880
  s_add_u32 m0, s38, 73728
  s_nop 0
  buffer_load_dwordx4 v11, s[12:15], s42 offen lds
  s_add_u32 s42, s45, 122880
  s_add_u32 m0, s38, 12288
  s_nop 0
  buffer_load_dwordx4 v10, s[8:11], s42 offen lds
  s_add_u32 s42, s44, 184320
  s_add_u32 m0, s38, 77824
  s_nop 0
  buffer_load_dwordx4 v11, s[12:15], s42 offen lds
  s_waitcnt vmcnt(8)
  s_barrier
  s_add_u32 s44, s43, 5
  s_cmp_ge_u32 s44, 10
  s_cselect_b32 s45, 10, 0
  s_sub_u32 s44, s44, s45
  s_lshl_b32 s45, s44, 7
  s_add_u32 s45, s45, s36
  s_mul_i32 s44, s44, 245760
  s_add_u32 s44, s44, s37
  s_add_u32 s42, s45, 0
  s_add_u32 m0, s38, 16384
  s_nop 0
  buffer_load_dwordx4 v10, s[8:11], s42 offen lds
  s_add_u32 s42, s44, 0
  s_add_u32 m0, s38, 81920
  s_nop 0
  buffer_load_dwordx4 v11, s[12:15], s42 offen lds
  s_add_u32 s42, s45, 40960
  s_add_u32 m0, s38, 20480
  s_nop 0
  buffer_load_dwordx4 v10, s[8:11], s42 offen lds
  s_add_u32 s42, s44, 61440
  s_add_u32 m0, s38, 86016
  s_nop 0
  buffer_load_dwordx4 v11, s[12:15], s42 offen lds
  s_add_u32 s42, s45, 81920
  s_add_u32 m0, s38, 24576
  s_nop 0
  buffer_load_dwordx4 v10, s[8:11], s42 offen lds
  s_add_u32 s42, s44, 122880
  s_add_u32 m0, s38, 90112
  s_nop 0
  buffer_load_dwordx4 v11, s[12:15], s42 offen lds
  s_add_u32 s42, s45, 122880
  s_add_u32 m0, s38, 28672
  s_nop 0
  buffer_load_dwordx4 v10, s[8:11], s42 offen lds
  s_add_u32 s42, s44, 184320
  s_add_u32 m0, s38, 94208
  s_nop 0
  buffer_load_dwordx4 v11, s[12:15], s42 offen lds
  s_waitcnt vmcnt(8)
  s_barrier
  s_add_u32 s44, s43, 6
  s_cmp_ge_u32 s44, 10
  s_cselect_b32 s45, 10, 0
  s_sub_u32 s44, s44, s45
  s_lshl_b32 s45, s44, 7
  s_add_u32 s45, s45, s36
  s_mul_i32 s44, s44, 245760
  s_add_u32 s44, s44, s37
  s_add_u32 s42, s45, 0
  s_add_u32 m0, s38, 32768
  s_nop 0
  buffer_load_dwordx4 v10, s[8:11], s42 offen lds
  s_add_u32 s42, s44, 0
  s_add_u32 m0, s38, 98304
  s_nop 0
  buffer_load_dwordx4 v11, s[12:15], s42 offen lds
  s_add_u32 s42, s45, 40960
  s_add_u32 m0, s38, 36864
  s_nop 0
  buffer_load_dwordx4 v10, s[8:11], s42 offen lds
  s_add_u32 s42, s44, 61440
  s_add_u32 m0, s38, 102400
  s_nop 0
  buffer_load_dwordx4 v11, s[12:15], s42 offen lds
  s_add_u32 s42, s45, 81920
  s_add_u32 m0, s38, 40960
  s_nop 0
  buffer_load_dwordx4 v10, s[8:11], s42 offen lds
  s_add_u32 s42, s44, 122880
  s_add_u32 m0, s38, 106496
  s_nop 0
  buffer_load_dwordx4 v11, s[12:15], s42 offen lds
  s_add_u32 s42, s45, 122880
  s_add_u32 m0, s38, 45056
  s_nop 0
  buffer_load_dwordx4 v10, s[8:11], s42 offen lds
  s_add_u32 s42, s44, 184320
  s_add_u32 m0, s38, 110592
  s_nop 0
  buffer_load_dwordx4 v11, s[12:15], s42 offen lds
  s_waitcnt vmcnt(8)
  s_barrier
  s_add_u32 s44, s43, 7
  s_cmp_ge_u32 s44, 10
  s_cselect_b32 s45, 10, 0
  s_sub_u32 s44, s44, s45
  s_lshl_b32 s45, s44, 7
  s_add_u32 s45, s45, s36
  s_mul_i32 s44, s44, 245760
  s_add_u32 s44, s44, s37
  s_add_u32 s42, s45, 0
  s_add_u32 m0, s38, 49152
  s_nop 0
  buffer_load_dwordx4 v10, s[8:11], s42 offen lds
  s_add_u32 s42, s44, 0
  s_add_u32 m0, s38, 114688
  s_nop 0
  buffer_load_dwordx4 v11, s[12:15], s42 offen lds
  s_add_u32 s42, s45, 40960
  s_add_u32 m0, s38, 53248
  s_nop 0
  buffer_load_dwordx4 v10, s[8:11], s42 offen lds
  s_add_u32 s42, s44, 61440
  s_add_u32 m0, s38, 118784
  s_nop 0
  buffer_load_dwordx4 v11, s[12:15], s42 offen lds
  s_add_u32 s42, s45, 81920
  s_add_u32 m0, s38, 57344
  s_nop 0
  buffer_load_dwordx4 v10, s[8:11], s42 offen lds
  s_add_u32 s42, s44, 122880
  s_add_u32 m0, s38, 122880
  s_nop 0
  buffer_load_dwordx4 v11, s[12:15], s42 offen lds
  s_add_u32 s42, s45, 122880
  s_add_u32 m0, s38, 61440
  s_nop 0
  buffer_load_dwordx4 v10, s[8:11], s42 offen lds
  s_add_u32 s42, s44, 184320
  s_add_u32 m0, s38, 126976
  s_nop 0
  buffer_load_dwordx4 v11, s[12:15], s42 offen lds
  s_waitcnt vmcnt(8)
  s_barrier
  s_add_u32 s44, s43, 8
  s_cmp_ge_u32 s44, 10
  s_cselect_b32 s45, 10, 0
  s_sub_u32 s44, s44, s45
  s_lshl_b32 s45, s44, 7
  s_add_u32 s45, s45, s36
  s_mul_i32 s44, s44, 245760
  s_add_u32 s44, s44, s37
  s_add_u32 s42, s45, 0
  s_add_u32 m0, s38, 0
  s_nop 0
  buffer_load_dwordx4 v10, s[8:11], s42 offen lds
  s_add_u32 s42, s44, 0
  s_add_u32 m0, s38, 65536
  s_nop 0
  buffer_load_dwordx4 v11, s[12:15], s42 offen lds
  s_add_u32 s42, s45, 40960
  s_add_u32 m0, s38, 4096
  s_nop 0
  buffer_load_dwordx4 v10, s[8:11], s42 offen lds
  s_add_u32 s42, s44, 61440
  s_add_u32 m0, s38, 69632
  s_nop 0
  buffer_load_dwordx4 v11, s[12:15], s42 offen lds
  s_add_u32 s42, s45, 81920
  s_add_u32 m0, s38, 8192
  s_nop 0
  buffer_load_dwordx4 v10, s[8:11], s42 offen lds
  s_add_u32 s42, s44, 122880
  s_add_u32 m0, s38, 73728
  s_nop 0
  buffer_load_dwordx4 v11, s[12:15], s42 offen lds
  s_add_u32 s42, s45, 122880
  s_add_u32 m0, s38, 12288
  s_nop 0
  buffer_load_dwordx4 v10, s[8:11], s42 offen lds
  s_add_u32 s42, s44, 184320
  s_add_u32 m0, s38, 77824
  s_nop 0
  buffer_load_dwordx4 v11, s[12:15], s42 offen lds
  s_waitcnt vmcnt(8)
  s_barrier
  s_add_u32 s44, s43, 9
  s_cmp_ge_u32 s44, 10
  s_cselect_b32 s45, 10, 0
  s_sub_u32 s44, s44, s45
  s_lshl_b32 s45, s44, 7
  s_add_u32 s45, s45, s36
  s_mul_i32 s44, s44, 245760
  s_add_u32 s44, s44, s37
  s_add_u32 s42, s45, 0
  s_add_u32 m0, s38, 16384
  s_nop 0
  buffer_load_dwordx4 v10, s[8:11], s42 offen lds
  s_add_u32 s42, s44, 0
  s_add_u32 m0, s38, 81920
  s_nop 0
  buffer_load_dwordx4 v11, s[12:15], s42 offen lds
  s_add_u32 s42, s45, 40960
  s_add_u32 m0, s38, 20480
  s_nop 0
  buffer_load_dwordx4 v10, s[8:11], s42 offen lds
  s_add_u32 s42, s44, 61440
  s_add_u32 m0, s38, 86016
  s_nop 0
  buffer_load_dwordx4 v11, s[12:15], s42 offen lds
  s_add_u32 s42, s45, 81920
  s_add_u32 m0, s38, 24576
  s_nop 0
  buffer_load_dwordx4 v10, s[8:11], s42 offen lds
  s_add_u32 s42, s44, 122880
  s_add_u32 m0, s38, 90112
  s_nop 0
  buffer_load_dwordx4 v11, s[12:15], s42 offen lds
  s_add_u32 s42, s45, 122880
  s_add_u32 m0, s38, 28672
  s_nop 0
  buffer_load_dwordx4 v10, s[8:11], s42 offen lds
  s_add_u32 s42, s44, 184320
  s_add_u32 m0, s38, 94208
  s_nop 0
  buffer_load_dwordx4 v11, s[12:15], s42 offen lds
  s_waitcnt vmcnt(8)
  s_barrier
  s_waitcnt vmcnt(0)
  s_barrier
  v_mov_b32 v6, 160784
  ds_read_b64 v[6:7], v6
  s_waitcnt lgkmcnt(0)
  v_readfirstlane_b32 s56, v6
  v_readfirstlane_b32 s57, v7
  s_and_b32 s38, s5, 0xfe
  s_lshl_b32 s38, s38, 11
  s_add_u32 s38, s38, 22216704
  v_and_b32 v5, 31, v1
  v_lshlrev_b32 v5, 7, v5
  s_mov_b32 s40, 0
Lpoll_64:
  s_add_u32 s40, s40, 1
  s_cmp_gt_u32 s40, 1048576
  s_cbranch_scc1 Lpollx_65
  buffer_load_dwordx2 v[6:7], v5, s[20:23], s38 offen sc1
  s_waitcnt vmcnt(0)
  v_cmp_eq_u32 vcc, s56, v6
  v_cmp_eq_u32 s[42:43], s57, v7
  s_nop 0
  s_and_b64 vcc, vcc, s[42:43]
  s_cmp_eq_u64 vcc, -1
  s_cbranch_scc0 Lpoll_64
Lpollx_65:
  s_cmp_eq_u32 s26, 3
  s_cbranch_scc1 Lsd3_66
  s_lshl_b32 s58, s26, 4
  s_add_u32 s58, s58, s4
  s_cmp_lt_u32 s58, 40
  s_cbranch_scc0 Lsde_67
  v_add_u32 v2, 0, v1
  v_mul_u32_u24 v3, 5462, v2
  v_lshrrev_b32 v3, 16, v3
  v_mul_u32_u24 v4, 12, v3
  v_sub_u32 v4, v2, v4
  v_mul_u32_u24 v3, 3072, v3
  v_lshl_add_u32 v5, v4, 4, v3
  v_add_u32 v2, 64, v1
  v_mul_u32_u24 v3, 5462, v2
  v_lshrrev_b32 v3, 16, v3
  v_mul_u32_u24 v4, 12, v3
  v_sub_u32 v4, v2, v4
  v_mul_u32_u24 v3, 3072, v3
  v_lshl_add_u32 v6, v4, 4, v3
  v_add_u32 v2, 128, v1
  v_mul_u32_u24 v3, 5462, v2
  v_lshrrev_b32 v3, 16, v3
  v_mul_u32_u24 v4, 12, v3
  v_sub_u32 v4, v2, v4
  v_mul_u32_u24 v3, 3072, v3
  v_lshl_add_u32 v7, v4, 4, v3
  s_mul_i32 s34, s58, 49152
  s_mul_i32 s35, s5, 192
  s_add_u32 s34, s34, s35
  s_mov_b32 s16, s70
  s_mov_b32 s17, s71
  s_mov_b32 s18, 0x1e0000
  buffer_load_dwordx4 v[64:67], v5, s[16:19], s34 offen
  buffer_load_dwordx4 v[68:71], v6, s[16:19], s34 offen
  buffer_load_dwordx4 v[72:75], v7, s[16:19], s34 offen
  s_mov_b32 s16, s72
  s_mov_b32 s17, s73
  s_mov_b32 s18, 0x1e0000
  buffer_load_dwordx4 v[76:79], v5, s[16:19], s34 offen
  buffer_load_dwordx4 v[80:83], v6, s[16:19], s34 offen
  buffer_load_dwordx4 v[84:87], v7, s[16:19], s34 offen
  s_branch Lsde_67
Lsd3_66:
  v_add_u32 v2, 0, v1
  v_mul_u32_u24 v3, 6554, v2
  v_lshrrev_b32 v3, 16, v3
  v_mul_u32_u24 v4, 10, v3
  v_sub_u32 v4, v2, v4
  v_mul_u32_u24 v3, 1280, v3
  v_lshl_add_u32 v5, v4, 4, v3
  v_add_u32 v2, 64, v1
  v_mul_u32_u24 v3, 6554, v2
  v_lshrrev_b32 v3, 16, v3
  v_mul_u32_u24 v4, 10, v3
  v_sub_u32 v4, v2, v4
  v_mul_u32_u24 v3, 1280, v3
  v_lshl_add_u32 v6, v4, 4, v3
  v_add_u32 v2, 128, v1
  v_mul_u32_u24 v3, 6554, v2
  v_lshrrev_b32 v3, 16, v3
  v_mul_u32_u24 v4, 10, v3
  v_sub_u32 v4, v2, v4
  v_mul_u32_u24 v3, 1280, v3
  v_lshl_add_u32 v7, v4, 4, v3
  v_add_u32 v2, 192, v1
  v_mul_u32_u24 v3, 6554, v2
  v_lshrrev_b32 v3, 16, v3
  v_mul_u32_u24 v4, 10, v3
  v_sub_u32 v4, v2, v4
  v_mul_u32_u24 v3, 1280, v3
  v_lshl_add_u32 v8, v4, 4, v3
  v_add_u32 v2, 256, v1
  v_mul_u32_u24 v3, 6554, v2
  v_lshrrev_b32 v3, 16, v3
  v_mul_u32_u24 v4, 10, v3
  v_sub_u32 v4, v2, v4
  v_mul_u32_u24 v3, 1280, v3
  v_lshl_add_u32 v9, v4, 4, v3
  s_mov_b32 s16, s74
  s_mov_b32 s17, s75
  s_mov_b32 s18, 0x1e0000
  s_lshl_b32 s58, s4, 1
  s_add_u32 s58, s58, s7
  s_mul_i32 s34, s58, 40960
  s_mul_i32 s35, s24, 160
  s_add_u32 s34, s34, s35
  buffer_load_dwordx4 v[64:67], v5, s[16:19], s34 offen
  buffer_load_dwordx4 v[68:71], v6, s[16:19], s34 offen
  buffer_load_dwordx4 v[72:75], v7, s[16:19], s34 offen
  buffer_load_dwordx4 v[76:79], v8, s[16:19], s34 offen
  buffer_load_dwordx4 v[80:83], v9, s[16:19], s34 offen
  s_cmp_lt_u32 s58, 16
  s_cbranch_scc0 Lsde_67
  s_add_u32 s34, s34, 1310720
  buffer_load_dwordx4 v[84:87], v5, s[16:19], s34 offen
  buffer_load_dwordx4 v[88:91], v6, s[16:19], s34 offen
  buffer_load_dwordx4 v[92:95], v7, s[16:19], s34 offen
  buffer_load_dwordx4 v[96:99], v8, s[16:19], s34 offen
  buffer_load_dwordx4 v[100:103], v9, s[16:19], s34 offen
Lsde_67:
  s_barrier
  v_mov_b32 v7, 0
  v_lshlrev_b32 v6, 2, v1
  v_add_u32 v6, 160800, v6
  s_mov_b64 exec, 0x1f
  ds_write_b32 v6, v7
  s_mov_b64 exec, -1
  s_waitcnt lgkmcnt(0)
  s_barrier
  v_mov_b32 v6, 160784
  ds_read_b64 v[6:7], v6
  s_waitcnt lgkmcnt(0)
  v_readfirstlane_b32 s56, v6
  v_readfirstlane_b32 s57, v7
  v_lshlrev_b32 v13, 4, v1
  s_mul_i32 s38, s26, 25600
  s_mul_i32 s35, s24, 102400
  s_add_u32 s35, s35, s38
  s_add_u32 s35, s35, 32505856
  s_add_u32 s42, s35, 0
  s_add_u32 m0, s38, 49664
  s_nop 0
  buffer_load_dwordx4 v13, s[20:23], s42 offen sc1 lds
  s_add_u32 s42, s35, 1024
  s_add_u32 m0, s38, 50688
  s_nop 0
  buffer_load_dwordx4 v13, s[20:23], s42 offen sc1 lds
  s_add_u32 s42, s35, 2048
  s_add_u32 m0, s38, 51712
  s_nop 0
  buffer_load_dwordx4 v13, s[20:23], s42 offen sc1 lds
  s_add_u32 s42, s35, 3072
  s_add_u32 m0, s38, 52736
  s_nop 0
  buffer_load_dwordx4 v13, s[20:23], s42 offen sc1 lds
  s_add_u32 s42, s35, 4096
  s_add_u32 m0, s38, 53760
  s_nop 0
  buffer_load_dwordx4 v13, s[20:23], s42 offen sc1 lds
  s_add_u32 s42, s35, 5120
  s_add_u32 m0, s38, 54784
  s_nop 0
  buffer_load_dwordx4 v13, s[20:23], s42 offen sc1 lds
  s_add_u32 s42, s35, 6144
  s_add_u32 m0, s38, 55808
  s_nop 0
  buffer_load_dwordx4 v13, s[20:23], s42 offen sc1 lds
  s_add_u32 s42, s35, 7168
  s_add_u32 m0, s38, 56832
  s_nop 0
  buffer_load_dwordx4 v13, s[20:23], s42 offen sc1 lds
  s_add_u32 s42, s35, 8192
  s_add_u32 m0, s38, 57856
  s_nop 0
  buffer_load_dwordx4 v13, s[20:23], s42 offen sc1 lds
  s_add_u32 s42, s35, 9216
  s_add_u32 m0, s38, 58880
  s_nop 0
  buffer_load_dwordx4 v13, s[20:23], s42 offen sc1 lds
  s_add_u32 s42, s35, 10240
  s_add_u32 m0, s38, 59904
  s_nop 0
  buffer_load_dwordx4 v13, s[20:23], s42 offen sc1 lds
  s_add_u32 s42, s35, 11264
  s_add_u32 m0, s38, 60928
  s_nop 0
  buffer_load_dwordx4 v13, s[20:23], s42 offen sc1 lds
  s_add_u32 s42, s35, 12288
  s_add_u32 m0, s38, 61952
  s_nop 0
  buffer_load_dwordx4 v13, s[20:23], s42 offen sc1 lds
  s_add_u32 s42, s35, 13312
  s_add_u32 m0, s38, 62976
  s_nop 0
  buffer_load_dwordx4 v13, s[20:23], s42 offen sc1 lds
  s_add_u32 s42, s35, 14336
  s_add_u32 m0, s38, 64000
  s_nop 0
  buffer_load_dwordx4 v13, s[20:23], s42 offen sc1 lds
  s_add_u32 s42, s35, 15360
  s_add_u32 m0, s38, 65024
  s_nop 0
  buffer_load_dwordx4 v13, s[20:23], s42 offen sc1 lds
  s_add_u32 s42, s35, 16384
  s_add_u32 m0, s38, 66048
  s_nop 0
  buffer_load_dwordx4 v13, s[20:23], s42 offen sc1 lds
  s_add_u32 s42, s35, 17408
  s_add_u32 m0, s38, 67072
  s_nop 0
  buffer_load_dwordx4 v13, s[20:23], s42 offen sc1 lds
  s_add_u32 s42, s35, 18432
  s_add_u32 m0, s38, 68096
  s_nop 0
  buffer_load_dwordx4 v13, s[20:23], s42 offen sc1 lds
  s_add_u32 s42, s35, 19456
  s_add_u32 m0, s38, 69120
  s_nop 0
  buffer_load_dwordx4 v13, s[20:23], s42 offen sc1 lds
  s_add_u32 s42, s35, 20480
  s_add_u32 m0, s38, 70144
  s_nop 0
  buffer_load_dwordx4 v13, s[20:23], s42 offen sc1 lds
  s_add_u32 s42, s35, 21504
  s_add_u32 m0, s38, 71168
  s_nop 0
  buffer_load_dwordx4 v13, s[20:23], s42 offen sc1 lds
  s_add_u32 s42, s35, 22528
  s_add_u32 m0, s38, 72192
  s_nop 0
  buffer_load_dwordx4 v13, s[20:23], s42 offen sc1 lds
  s_add_u32 s42, s35, 23552
  s_add_u32 m0, s38, 73216
  s_nop 0
  buffer_load_dwordx4 v13, s[20:23], s42 offen sc1 lds
  s_add_u32 s42, s35, 24576
  s_add_u32 m0, s38, 74240
  s_nop 0
  buffer_load_dwordx4 v13, s[20:23], s42 offen sc1 lds
  s_mul_i32 s34, s26, 20
  v_add_u32 v2, s34, v1
  v_mul_u32_u24 v3, 6554, v2
  v_lshrrev_b32 v3, 16, v3
  v_mul_u32_u24 v4, 10, v3
  v_sub_u32 v4, v2, v4
  s_lshl_b32 s34, s6, 10
  v_lshl_add_u32 v5, v4, 7, s34
  s_lshr_b32 s35, s6, 2
  s_add_u32 s35, s35, 16
  s_lshl_b32 s35, s35, 10
  s_and_b32 s36, s6, 3
  s_lshl_b32 s36, s36, 8
  s_add_u32 s35, s35, s36
  s_sub_u32 s35, s35, 1024
  v_lshl_add_u32 v6, v4, 7, s35
  v_cmp_gt_u32 vcc, 8, v4
  s_nop 1
  v_cndmask_b32 v5, v6, v5, vcc
  v_mul_u32_u24 v3, 20480, v3
  v_add_u32 v5, v5, v3
  s_mul_i32 s34, s4, 163840
  s_add_u32 s34, s34, 7340032
  s_mov_b64 exec, 0xfffff
  buffer_load_dword v250, v5, s[20:23], s34 offen
  s_mov_b64 exec, -1
  s_mul_i32 s34, s26, 20
  v_add_u32 v2, s34, v1
  v_cmp_le_u32 vcc, 40, v2
  s_nop 1
  v_cndmask_b32 v3, 0, 1, vcc
  v_mul_u32_u24 v4, 40, v3
  v_sub_u32 v4, v2, v4
  v_mul_u32_u24 v3, 40960, v3
  v_lshl_add_u32 v5, v4, 7, v3
  s_lshl_b32 s34, s4, 2
  s_lshl_b32 s35, s7, 1
  s_add_u32 s34, s34, s35
  s_mul_i32 s34, s34, 40
  s_mul_i32 s35, s24, 5
  s_add_u32 s34, s34, s35
  s_lshl_b32 s34, s34, 10
  s_add_u32 s34, s34, 10485760
  s_mov_b64 exec, 0xfffff
  buffer_load_dword v250, v5, s[20:23], s34 offen
  s_lshl_b32 s34, s4, 3
  s_add_u32 s34, s34, s24
  s_lshl_b32 s34, s34, 10
  s_lshl_b32 s35, s7, 9
  s_add_u32 s34, s34, s35
  s_lshl_b32 s35, s26, 7
  s_add_u32 s34, s34, s35
  s_add_u32 s34, s34, 13631488
  v_mov_b32 v5, 0
  s_mov_b64 exec, 1
  buffer_load_dword v250, v5, s[20:23], s34 offen
  s_mov_b64 exec, -1
  s_barrier
  s_waitcnt vmcnt(28)
  v_lshlrev_b32 v13, 4, v1
  v_lshrrev_b32 v4, 4, v1
  v_bfe_u32 v5, v1, 2, 2
  v_and_b32 v6, 3, v1
  s_cmp_eq_u32 s26, 3
  s_cbranch_scc1 Lsp3_68
  s_mul_i32 s36, s26, 768
  s_add_u32 s36, s36, 29440
  s_cmp_lt_u32 s58, 40
  s_cbranch_scc0 Lspz_70
  s_mul_i32 s35, s26, 6400
  s_add_u32 s35, s35, 0
  v_add_u32 v7, s35, v13
  ds_write_b128 v7, v[64:67] offset:0
  ds_write_b128 v7, v[76:79] offset:3104
  ds_write_b128 v7, v[68:71] offset:1024
  ds_write_b128 v7, v[80:83] offset:4128
  ds_write_b128 v7, v[72:75] offset:2048
  ds_write_b128 v7, v[84:87] offset:5152
  v_lshrrev_b32 v8, 1, v4
  v_lshl_add_u32 v8, v8, 3, v5
  v_mul_u32_u24 v8, 192, v8
  v_lshl_add_u32 v8, v6, 3, v8
  v_add_u32 v8, s35, v8
  v_and_b32 v9, 1, v4
  v_lshl_add_u32 v10, v9, 5, v8
  v_add_u32 v11, 3104, v10
  v_mul_u32_u24 v9, 3104, v9
  v_add_u32 v12, v9, v8
  v_add_u32 v12, 64, v12
  s_waitcnt lgkmcnt(0)
  ds_read_b64_tr_b16 v[88:89], v10 offset:0
  ds_read_b64_tr_b16 v[90:91], v10 offset:768
  ds_read_b64_tr_b16 v[92:93], v11 offset:0
  ds_read_b64_tr_b16 v[94:95], v11 offset:768
  ds_read_b64_tr_b16 v[96:97], v12 offset:0
  ds_read_b64_tr_b16 v[98:99], v12 offset:768
  ds_read_b64_tr_b16 v[100:101], v10 offset:96
  ds_read_b64_tr_b16 v[102:103], v10 offset:864
  ds_read_b64_tr_b16 v[104:105], v11 offset:96
  ds_read_b64_tr_b16 v[106:107], v11 offset:864
  ds_read_b64_tr_b16 v[108:109], v12 offset:96
  ds_read_b64_tr_b16 v[110:111], v12 offset:864
  s_mul_i32 s34, s5, 40
  s_add_u32 s34, s34, s58
  s_mul_i32 s34, s34, 6144
  s_add_u32 s34, s34, 25165824
  s_mov_b32 s59, s34
  s_waitcnt lgkmcnt(0)
  v_and_b32 v2, 31, v1
  v_lshlrev_b32 v3, 2, v2
  v_add_u32 v3, s36, v3
  v_cmp_le_u32 vcc, 16, v2
  s_nop 1
  v_cndmask_b32 v14, 0, 1, vcc
  v_mul_u32_u24 v14, 320, v14
  v_add_u32 v14, v14, v3
  v_lshlrev_b32 v112, 16, v88
  v_and_b32 v113, 0xffff0000, v88
  v_lshlrev_b32 v114, 16, v89
  v_and_b32 v115, 0xffff0000, v89
  v_lshlrev_b32 v116, 16, v90
  v_and_b32 v117, 0xffff0000, v90
  v_lshlrev_b32 v118, 16, v91
  v_and_b32 v119, 0xffff0000, v91
  v_pk_add_f32 v[112:113], v[112:113], v[114:115]
  v_pk_add_f32 v[116:117], v[116:117], v[118:119]
  v_pk_add_f32 v[112:113], v[112:113], v[116:117]
  v_add_f32 v112, v112, v113
  v_mov_b32 v113, v112
  s_nop 1
  v_permlane32_swap_b32 v112, v113
  v_add_f32 v112, v112, v113
  ds_write_b32 v3, v112 offset:0
  v_lshlrev_b32 v112, 16, v92
  v_and_b32 v113, 0xffff0000, v92
  v_lshlrev_b32 v114, 16, v93
  v_and_b32 v115, 0xffff0000, v93
  v_lshlrev_b32 v116, 16, v94
  v_and_b32 v117, 0xffff0000, v94
  v_lshlrev_b32 v118, 16, v95
  v_and_b32 v119, 0xffff0000, v95
  v_pk_add_f32 v[112:113], v[112:113], v[114:115]
  v_pk_add_f32 v[116:117], v[116:117], v[118:119]
  v_pk_add_f32 v[112:113], v[112:113], v[116:117]
  v_add_f32 v112, v112, v113
  v_mov_b32 v113, v112
  s_nop 1
  v_permlane32_swap_b32 v112, v113
  v_add_f32 v112, v112, v113
  ds_write_b32 v3, v112 offset:384
  v_lshlrev_b32 v112, 16, v96
  v_and_b32 v113, 0xffff0000, v96
  v_lshlrev_b32 v114, 16, v97
  v_and_b32 v115, 0xffff0000, v97
  v_lshlrev_b32 v116, 16, v98
  v_and_b32 v117, 0xffff0000, v98
  v_lshlrev_b32 v118, 16, v99
  v_and_b32 v119, 0xffff0000, v99
  v_pk_add_f32 v[112:113], v[112:113], v[114:115]
  v_pk_add_f32 v[116:117], v[116:117], v[118:119]
  v_pk_add_f32 v[112:113], v[112:113], v[116:117]
  v_add_f32 v112, v112, v113
  v_mov_b32 v113, v112
  s_nop 1
  v_permlane32_swap_b32 v112, v113
  v_add_f32 v112, v112, v113
  ds_write_b32 v14, v112 offset:128
  v_lshlrev_b32 v112, 16, v100
  v_and_b32 v113, 0xffff0000, v100
  v_lshlrev_b32 v114, 16, v101
  v_and_b32 v115, 0xffff0000, v101
  v_lshlrev_b32 v116, 16, v102
  v_and_b32 v117, 0xffff0000, v102
  v_lshlrev_b32 v118, 16, v103
  v_and_b32 v119, 0xffff0000, v103
  v_pk_add_f32 v[112:113], v[112:113], v[114:115]
  v_pk_add_f32 v[116:117], v[116:117], v[118:119]
  v_pk_add_f32 v[112:113], v[112:113], v[116:117]
  v_add_f32 v112, v112, v113
  v_mov_b32 v113, v112
  s_nop 1
  v_permlane32_swap_b32 v112, v113
  v_add_f32 v112, v112, v113
  ds_write_b32 v3, v112 offset:192
  v_lshlrev_b32 v112, 16, v104
  v_and_b32 v113, 0xffff0000, v104
  v_lshlrev_b32 v114, 16, v105
  v_and_b32 v115, 0xffff0000, v105
  v_lshlrev_b32 v116, 16, v106
  v_and_b32 v117, 0xffff0000, v106
  v_lshlrev_b32 v118, 16, v107
  v_and_b32 v119, 0xffff0000, v107
  v_pk_add_f32 v[112:113], v[112:113], v[114:115]
  v_pk_add_f32 v[116:117], v[116:117], v[118:119]
  v_pk_add_f32 v[112:113], v[112:113], v[116:117]
  v_add_f32 v112, v112, v113
  v_mov_b32 v113, v112
  s_nop 1
  v_permlane32_swap_b32 v112, v113
  v_add_f32 v112, v112, v113
  ds_write_b32 v3, v112 offset:576
  v_lshlrev_b32 v112, 16, v108
  v_and_b32 v113, 0xffff0000, v108
  v_lshlrev_b32 v114, 16, v109
  v_and_b32 v115, 0xffff0000, v109
  v_lshlrev_b32 v116, 16, v110
  v_and_b32 v117, 0xffff0000, v110
  v_lshlrev_b32 v118, 16, v111
  v_and_b32 v119, 0xffff0000, v111
  v_pk_add_f32 v[112:113], v[112:113], v[114:115]
  v_pk_add_f32 v[116:117], v[116:117], v[118:119]
  v_pk_add_f32 v[112:113], v[112:113], v[116:117]
  v_add_f32 v112, v112, v113
  v_mov_b32 v113, v112
  s_nop 1
  v_permlane32_swap_b32 v112, v113
  v_add_f32 v112, v112, v113
  ds_write_b32 v14, v112 offset:320
  s_branch Lspe_69
Lspz_70:
  v_mov_b32 v2, 0
  v_mov_b32 v3, 0
  v_lshlrev_b32 v7, 3, v1
  v_add_u32 v7, s36, v7
  ds_write_b64 v7, v[2:3]
  s_mov_b32 exec_hi, 0
  ds_write_b64 v7, v[2:3] offset:512
  s_mov_b64 exec, -1
  s_branch Lspe_69
Lsp3_68:
  v_add_u32 v7, 19200, v13
  v_lshrrev_b32 v8, 1, v4
  v_lshlrev_b32 v8, 4, v8
  v_and_b32 v9, 1, v4
  v_lshl_add_u32 v8, v9, 2, v8
  v_add_u32 v8, v8, v5
  v_mul_u32_u24 v8, 160, v8
  v_lshl_add_u32 v8, v6, 3, v8
  v_add_u32 v8, 19200, v8
  s_mul_i32 s34, s24, 48
  s_add_u32 s34, s34, s58
  s_mul_i32 s34, s34, 5120
  s_add_u32 s34, s34, 29360128
  s_mov_b32 s59, s34
  ds_write_b128 v7, v[64:67] offset:0
  ds_write_b128 v7, v[68:71] offset:1024
  ds_write_b128 v7, v[72:75] offset:2048
  ds_write_b128 v7, v[76:79] offset:3072
  ds_write_b128 v7, v[80:83] offset:4096
  s_waitcnt lgkmcnt(0)
  ds_read_b64_tr_b16 v[124:125], v8 offset:0
  ds_read_b64_tr_b16 v[126:127], v8 offset:1280
  ds_read_b64_tr_b16 v[128:129], v8 offset:32
  ds_read_b64_tr_b16 v[130:131], v8 offset:1312
  ds_read_b64_tr_b16 v[132:133], v8 offset:64
  ds_read_b64_tr_b16 v[134:135], v8 offset:1344
  ds_read_b64_tr_b16 v[136:137], v8 offset:96
  ds_read_b64_tr_b16 v[138:139], v8 offset:1376
  ds_read_b64_tr_b16 v[140:141], v8 offset:128
  ds_read_b64_tr_b16 v[142:143], v8 offset:1408
  s_cmp_lt_u32 s58, 16
  s_cbranch_scc0 Lspe_69
  ds_write_b128 v7, v[84:87] offset:5120
  ds_write_b128 v7, v[88:91] offset:6144
  ds_write_b128 v7, v[92:95] offset:7168
  ds_write_b128 v7, v[96:99] offset:8192
  ds_write_b128 v7, v[100:103] offset:9216
  s_waitcnt lgkmcnt(0)
  ds_read_b64_tr_b16 v[144:145], v8 offset:5120
  ds_read_b64_tr_b16 v[146:147], v8 offset:6400
  ds_read_b64_tr_b16 v[148:149], v8 offset:5152
  ds_read_b64_tr_b16 v[150:151], v8 offset:6432
  ds_read_b64_tr_b16 v[152:153], v8 offset:5184
  ds_read_b64_tr_b16 v[154:155], v8 offset:6464
  ds_read_b64_tr_b16 v[156:157], v8 offset:5216
  ds_read_b64_tr_b16 v[158:159], v8 offset:6496
  ds_read_b64_tr_b16 v[160:161], v8 offset:5248
  ds_read_b64_tr_b16 v[162:163], v8 offset:6528
Lspe_69:
  s_waitcnt lgkmcnt(0)
  v_lshlrev_b32 v13, 4, v1
  s_cmp_eq_u32 s26, 3
  s_cbranch_scc1 Lss3_71
  s_cmp_lt_u32 s58, 40
  s_cbranch_scc0 Lsse_72
  s_add_u32 s35, s59, 0
  buffer_store_dwordx4 v[88:91], v13, s[20:23], s35 offen sc1
  s_add_u32 s35, s59, 1024
  buffer_store_dwordx4 v[92:95], v13, s[20:23], s35 offen sc1
  s_add_u32 s35, s59, 2048
  buffer_store_dwordx4 v[96:99], v13, s[20:23], s35 offen sc1
  s_add_u32 s35, s59, 3072
  buffer_store_dwordx4 v[100:103], v13, s[20:23], s35 offen sc1
  s_add_u32 s35, s59, 4096
  buffer_store_dwordx4 v[104:107], v13, s[20:23], s35 offen sc1
  s_add_u32 s35, s59, 5120
  buffer_store_dwordx4 v[108:111], v13, s[20:23], s35 offen sc1
  s_branch Lsse_72
Lss3_71:
  s_add_u32 s35, s59, 0
  buffer_store_dwordx4 v[124:127], v13, s[20:23], s35 offen sc1
  s_add_u32 s35, s59, 1024
  buffer_store_dwordx4 v[128:131], v13, s[20:23], s35 offen sc1
  s_add_u32 s35, s59, 2048
  buffer_store_dwordx4 v[132:135], v13, s[20:23], s35 offen sc1
  s_add_u32 s35, s59, 3072
  buffer_store_dwordx4 v[136:139], v13, s[20:23], s35 offen sc1
  s_add_u32 s35, s59, 4096
  buffer_store_dwordx4 v[140:143], v13, s[20:23], s35 offen sc1
  s_cmp_lt_u32 s58, 16
  s_cbranch_scc0 Lsse_72
  s_add_u32 s35, s59, 163840
  buffer_store_dwordx4 v[144:147], v13, s[20:23], s35 offen sc1
  s_add_u32 s35, s59, 164864
  buffer_store_dwordx4 v[148:151], v13, s[20:23], s35 offen sc1
  s_add_u32 s35, s59, 165888
  buffer_store_dwordx4 v[152:155], v13, s[20:23], s35 offen sc1
  s_add_u32 s35, s59, 166912
  buffer_store_dwordx4 v[156:159], v13, s[20:23], s35 offen sc1
  s_add_u32 s35, s59, 167936
  buffer_store_dwordx4 v[160:163], v13, s[20:23], s35 offen sc1
Lsse_72:
  s_barrier
  v_subrev_u32 v5, 256, v0
  v_cmp_gt_u32 vcc, 192, v5
  s_nop 0
  s_and_saveexec_b64 s[46:47], vcc
  s_cbranch_execz Lcs2_73
  v_lshlrev_b32 v6, 2, v5
  v_add_u32 v7, 29440, v6
  ds_read_b32 v16, v7
  ds_read_b32 v17, v7 offset:768
  ds_read_b32 v18, v7 offset:1536
  s_lshl_b32 s34, s5, 4
  s_add_u32 s34, s34, s4
  s_mul_i32 s34, s34, 768
  s_add_u32 s34, s34, 13893632
  s_waitcnt lgkmcnt(0)
  v_add_f32 v16, v16, v17
  v_add_f32 v16, v16, v18
  buffer_store_dword v16, v6, s[20:23], s34 offen sc1
Lcs2_73:
  s_mov_b64 exec, s[46:47]
  s_waitcnt vmcnt(0)
  v_subrev_u32 v5, 256, v0
  v_cmp_gt_u32 vcc, 88, v5
  s_nop 0
  s_and_saveexec_b64 s[36:37], vcc
  s_cbranch_execz Lzp2_74
  v_cmp_le_u32 vcc, 44, v5
  s_nop 1
  v_cndmask_b32 v6, 0, 1, vcc
  v_mul_u32_u24 v7, 44, v6
  v_sub_u32 v7, v5, v7
  v_lshrrev_b32 v8, 1, v7
  v_and_b32 v9, 1, v7
  v_subrev_u32 v10, 20, v8
  v_lshl_add_u32 v10, v10, 2, 24
  v_cmp_gt_u32 vcc, 20, v8
  s_nop 1
  v_cndmask_b32 v10, v10, v8, vcc
  v_mul_u32_u24 v10, 96, v10
  v_mul_u32_u24 v6, 3072, v6
  v_mul_u32_u24 v9, 48, v9
  v_add3_u32 v10, v10, v6, v9
  v_add_u32 v10, 153640, v10
  v_mov_b32 v12, 0
  v_mov_b32 v13, 0
  ds_write_b64 v10, v[12:13]
Lzp2_74:
  s_mov_b64 exec, s[36:37]
  s_waitcnt lgkmcnt(0)
  s_barrier
  s_cmp_eq_u32 s3, 4
  s_cbranch_scc0 Lf5_75
  s_lshl_b32 s38, s5, 11
  s_lshl_b32 s39, s4, 7
  s_add_u32 s38, s38, s39
  s_add_u32 s38, s38, 22183936
  v_mov_b32 v6, s56
  v_mov_b32 v7, s57
  v_mov_b32 v5, 0
  s_mov_b64 exec, 1
  buffer_store_dwordx2 v[6:7], v5, s[20:23], s38 offen sc1
  s_mov_b64 exec, -1
Lf5_75:
  s_barrier
  s_barrier
  s_and_b32 s38, s5, 0xfe
  s_lshl_b32 s38, s38, 11
  s_add_u32 s38, s38, 22183936
  v_and_b32 v5, 31, v1
  v_lshlrev_b32 v5, 7, v5
  s_mov_b32 s40, 0
Lpoll_76:
  s_add_u32 s40, s40, 1
  s_cmp_gt_u32 s40, 1048576
  s_cbranch_scc1 Lpollx_77
  buffer_load_dwordx2 v[6:7], v5, s[20:23], s38 offen sc1
  s_waitcnt vmcnt(0)
  v_cmp_eq_u32 vcc, s56, v6
  v_cmp_eq_u32 s[42:43], s57, v7
  s_nop 0
  s_and_b64 vcc, vcc, s[42:43]
  s_cmp_eq_u64 vcc, -1
  s_cbranch_scc0 Lpoll_76
Lpollx_77:
  v_subrev_u32 v5, 256, v0
  v_lshlrev_b32 v14, 2, v5
  s_mul_i32 s40, s5, 12288
  s_add_u32 s40, s40, 13893632
  s_cmp_eq_u32 s26, 3
  s_cbranch_scc1 Lnocs_78
  s_add_u32 s41, s40, 0
  buffer_load_dword v16, v14, s[20:23], s41 offen sc1
  s_add_u32 s41, s40, 768
  buffer_load_dword v17, v14, s[20:23], s41 offen sc1
  s_add_u32 s41, s40, 1536
  buffer_load_dword v18, v14, s[20:23], s41 offen sc1
  s_add_u32 s41, s40, 2304
  buffer_load_dword v19, v14, s[20:23], s41 offen sc1
  s_add_u32 s41, s40, 3072
  buffer_load_dword v20, v14, s[20:23], s41 offen sc1
  s_add_u32 s41, s40, 3840
  buffer_load_dword v21, v14, s[20:23], s41 offen sc1
  s_add_u32 s41, s40, 4608
  buffer_load_dword v22, v14, s[20:23], s41 offen sc1
  s_add_u32 s41, s40, 5376
  buffer_load_dword v23, v14, s[20:23], s41 offen sc1
  s_add_u32 s41, s40, 6144
  buffer_load_dword v24, v14, s[20:23], s41 offen sc1
  s_add_u32 s41, s40, 6912
  buffer_load_dword v25, v14, s[20:23], s41 offen sc1
  s_add_u32 s41, s40, 7680
  buffer_load_dword v26, v14, s[20:23], s41 offen sc1
  s_add_u32 s41, s40, 8448
  buffer_load_dword v27, v14, s[20:23], s41 offen sc1
  s_add_u32 s41, s40, 9216
  buffer_load_dword v28, v14, s[20:23], s41 offen sc1
  s_add_u32 s41, s40, 9984
  buffer_load_dword v29, v14, s[20:23], s41 offen sc1
  s_add_u32 s41, s40, 10752
  buffer_load_dword v30, v14, s[20:23], s41 offen sc1
  s_add_u32 s41, s40, 11520
  buffer_load_dword v31, v14, s[20:23], s41 offen sc1
Lnocs_78:
  v_lshlrev_b32 v13, 4, v1
  s_mul_i32 s50, s5, 245760
  s_mul_i32 s37, s26, 6144
  s_add_u32 s50, s50, s37
  s_add_u32 s50, s50, 25165824
  s_mov_b32 s51, s37
  s_and_b32 s52, s2, 7
  s_mul_i32 s52, s52, 5
  s_lshr_b32 s52, s52, 2
  s_add_u32 s44, s52, 0
  s_cmp_ge_u32 s44, 10
  s_cselect_b32 s45, 10, 0
  s_sub_u32 s44, s44, s45
  s_mul_i32 s44, s44, 24576
  s_add_u32 s44, s44, s50
  s_add_u32 s42, s44, 0
  s_add_u32 m0, s51, 0
  s_nop 0
  buffer_load_dwordx4 v13, s[20:23], s42 offen sc1 lds
  s_add_u32 s42, s44, 1024
  s_add_u32 m0, s51, 1024
  s_nop 0
  buffer_load_dwordx4 v13, s[20:23], s42 offen sc1 lds
  s_add_u32 s42, s44, 2048
  s_add_u32 m0, s51, 2048
  s_nop 0
  buffer_load_dwordx4 v13, s[20:23], s42 offen sc1 lds
  s_add_u32 s42, s44, 3072
  s_add_u32 m0, s51, 3072
  s_nop 0
  buffer_load_dwordx4 v13, s[20:23], s42 offen sc1 lds
  s_add_u32 s42, s44, 4096
  s_add_u32 m0, s51, 4096
  s_nop 0
  buffer_load_dwordx4 v13, s[20:23], s42 offen sc1 lds
  s_add_u32 s42, s44, 5120
  s_add_u32 m0, s51, 5120
  s_nop 0
  buffer_load_dwordx4 v13, s[20:23], s42 offen sc1 lds
  s_add_u32 s44, s52, 1
  s_cmp_ge_u32 s44, 10
  s_cselect_b32 s45, 10, 0
  s_sub_u32 s44, s44, s45
  s_mul_i32 s44, s44, 24576
  s_add_u32 s44, s44, s50
  s_add_u32 s42, s44, 0
  s_add_u32 m0, s51, 24576
  s_nop 0
  buffer_load_dwordx4 v13, s[20:23], s42 offen sc1 lds
  s_add_u32 s42, s44, 1024
  s_add_u32 m0, s51, 25600
  s_nop 0
  buffer_load_dwordx4 v13, s[20:23], s42 offen sc1 lds
  s_add_u32 s42, s44, 2048
  s_add_u32 m0, s51, 26624
  s_nop 0
  buffer_load_dwordx4 v13, s[20:23], s42 offen sc1 lds
  s_add_u32 s42, s44, 3072
  s_add_u32 m0, s51, 27648
  s_nop 0
  buffer_load_dwordx4 v13, s[20:23], s42 offen sc1 lds
  s_add_u32 s42, s44, 4096
  s_add_u32 m0, s51, 28672
  s_nop 0
  buffer_load_dwordx4 v13, s[20:23], s42 offen sc1 lds
  s_add_u32 s42, s44, 5120
  s_add_u32 m0, s51, 29696
  s_nop 0
  buffer_load_dwordx4 v13, s[20:23], s42 offen sc1 lds
  s_cmp_eq_u32 s26, 3
  s_cbranch_scc1 Lnocs2_79
  s_waitcnt vmcnt(12)
  v_add_f32 v16, v16, v17
  v_add_f32 v16, v16, v18
  v_add_f32 v16, v16, v19
  v_add_f32 v16, v16, v20
  v_add_f32 v16, v16, v21
  v_add_f32 v16, v16, v22
  v_add_f32 v16, v16, v23
  v_add_f32 v16, v16, v24
  v_add_f32 v16, v16, v25
  v_add_f32 v16, v16, v26
  v_add_f32 v16, v16, v27
  v_add_f32 v16, v16, v28
  v_add_f32 v16, v16, v29
  v_add_f32 v16, v16, v30
  v_add_f32 v16, v16, v31
  v_add_u32 v14, 161024, v14
  ds_write_b32 v14, v16
  s_waitcnt lgkmcnt(0)
Lnocs2_79:
  s_lshl_b32 s53, s4, 2
  s_add_u32 s53, s53, s26
  s_mul_i32 s53, s53, 40960
  s_add_u32 s53, s53, 10485760
  s_lshl_b32 s54, s26, 12
  s_barrier
  s_barrier
  s_add_u32 s44, s52, 0
  s_cmp_ge_u32 s44, 10
  s_cselect_b32 s45, 10, 0
  s_sub_u32 s44, s44, s45
  s_lshl_b32 s44, s44, 12
  s_add_u32 s44, s44, s53
  s_add_u32 s42, s44, 0
  s_add_u32 m0, s54, 98304
  s_nop 0
  buffer_load_dwordx4 v13, s[20:23], s42 offen sc1 lds
  s_add_u32 s42, s44, 1024
  s_add_u32 m0, s54, 99328
  s_nop 0
  buffer_load_dwordx4 v13, s[20:23], s42 offen sc1 lds
  s_add_u32 s42, s44, 2048
  s_add_u32 m0, s54, 100352
  s_nop 0
  buffer_load_dwordx4 v13, s[20:23], s42 offen sc1 lds
  s_add_u32 s42, s44, 3072
  s_add_u32 m0, s54, 101376
  s_nop 0
  buffer_load_dwordx4 v13, s[20:23], s42 offen sc1 lds
  s_add_u32 s44, s52, 1
  s_cmp_ge_u32 s44, 10
  s_cselect_b32 s45, 10, 0
  s_sub_u32 s44, s44, s45
  s_lshl_b32 s44, s44, 12
  s_add_u32 s44, s44, s53
  s_add_u32 s42, s44, 0
  s_add_u32 m0, s54, 114688
  s_nop 0
  buffer_load_dwordx4 v13, s[20:23], s42 offen sc1 lds
  s_add_u32 s42, s44, 1024
  s_add_u32 m0, s54, 115712
  s_nop 0
  buffer_load_dwordx4 v13, s[20:23], s42 offen sc1 lds
  s_add_u32 s42, s44, 2048
  s_add_u32 m0, s54, 116736
  s_nop 0
  buffer_load_dwordx4 v13, s[20:23], s42 offen sc1 lds
  s_add_u32 s42, s44, 3072
  s_add_u32 m0, s54, 117760
  s_nop 0
  buffer_load_dwordx4 v13, s[20:23], s42 offen sc1 lds
  s_add_u32 s44, s52, 2
  s_cmp_ge_u32 s44, 10
  s_cselect_b32 s45, 10, 0
  s_sub_u32 s44, s44, s45
  s_mul_i32 s44, s44, 24576
  s_add_u32 s44, s44, s50
  s_add_u32 s42, s44, 0
  s_add_u32 m0, s51, 49152
  s_nop 0
  buffer_load_dwordx4 v13, s[20:23], s42 offen sc1 lds
  s_add_u32 s42, s44, 1024
  s_add_u32 m0, s51, 50176
  s_nop 0
  buffer_load_dwordx4 v13, s[20:23], s42 offen sc1 lds
  s_add_u32 s42, s44, 2048
  s_add_u32 m0, s51, 51200
  s_nop 0
  buffer_load_dwordx4 v13, s[20:23], s42 offen sc1 lds
  s_add_u32 s42, s44, 3072
  s_add_u32 m0, s51, 52224
  s_nop 0
  buffer_load_dwordx4 v13, s[20:23], s42 offen sc1 lds
  s_add_u32 s42, s44, 4096
  s_add_u32 m0, s51, 53248
  s_nop 0
  buffer_load_dwordx4 v13, s[20:23], s42 offen sc1 lds
  s_add_u32 s42, s44, 5120
  s_add_u32 m0, s51, 54272
  s_nop 0
  buffer_load_dwordx4 v13, s[20:23], s42 offen sc1 lds
  s_waitcnt vmcnt(10)
  s_barrier
  s_add_u32 s44, s52, 2
  s_cmp_ge_u32 s44, 10
  s_cselect_b32 s45, 10, 0
  s_sub_u32 s44, s44, s45
  s_lshl_b32 s44, s44, 12
  s_add_u32 s44, s44, s53
  s_add_u32 s42, s44, 0
  s_add_u32 m0, s54, 131072
  s_nop 0
  buffer_load_dwordx4 v13, s[20:23], s42 offen sc1 lds
  s_add_u32 s42, s44, 1024
  s_add_u32 m0, s54, 132096
  s_nop 0
  buffer_load_dwordx4 v13, s[20:23], s42 offen sc1 lds
  s_add_u32 s42, s44, 2048
  s_add_u32 m0, s54, 133120
  s_nop 0
  buffer_load_dwordx4 v13, s[20:23], s42 offen sc1 lds
  s_add_u32 s42, s44, 3072
  s_add_u32 m0, s54, 134144
  s_nop 0
  buffer_load_dwordx4 v13, s[20:23], s42 offen sc1 lds
  s_add_u32 s44, s52, 3
  s_cmp_ge_u32 s44, 10
  s_cselect_b32 s45, 10, 0
  s_sub_u32 s44, s44, s45
  s_mul_i32 s44, s44, 24576
  s_add_u32 s44, s44, s50
  s_add_u32 s42, s44, 0
  s_add_u32 m0, s51, 73728
  s_nop 0
  buffer_load_dwordx4 v13, s[20:23], s42 offen sc1 lds
  s_add_u32 s42, s44, 1024
  s_add_u32 m0, s51, 74752
  s_nop 0
  buffer_load_dwordx4 v13, s[20:23], s42 offen sc1 lds
  s_add_u32 s42, s44, 2048
  s_add_u32 m0, s51, 75776
  s_nop 0
  buffer_load_dwordx4 v13, s[20:23], s42 offen sc1 lds
  s_add_u32 s42, s44, 3072
  s_add_u32 m0, s51, 76800
  s_nop 0
  buffer_load_dwordx4 v13, s[20:23], s42 offen sc1 lds
  s_add_u32 s42, s44, 4096
  s_add_u32 m0, s51, 77824
  s_nop 0
  buffer_load_dwordx4 v13, s[20:23], s42 offen sc1 lds
  s_add_u32 s42, s44, 5120
  s_add_u32 m0, s51, 78848
  s_nop 0
  buffer_load_dwordx4 v13, s[20:23], s42 offen sc1 lds
  s_waitcnt vmcnt(16)
  s_barrier
  s_add_u32 s44, s52, 3
  s_cmp_ge_u32 s44, 10
  s_cselect_b32 s45, 10, 0
  s_sub_u32 s44, s44, s45
  s_lshl_b32 s44, s44, 12
  s_add_u32 s44, s44, s53
  s_add_u32 s42, s44, 0
  s_add_u32 m0, s54, 98304
  s_nop 0
  buffer_load_dwordx4 v13, s[20:23], s42 offen sc1 lds
  s_add_u32 s42, s44, 1024
  s_add_u32 m0, s54, 99328
  s_nop 0
  buffer_load_dwordx4 v13, s[20:23], s42 offen sc1 lds
  s_add_u32 s42, s44, 2048
  s_add_u32 m0, s54, 100352
  s_nop 0
  buffer_load_dwordx4 v13, s[20:23], s42 offen sc1 lds
  s_add_u32 s42, s44, 3072
  s_add_u32 m0, s54, 101376
  s_nop 0
  buffer_load_dwordx4 v13, s[20:23], s42 offen sc1 lds
  s_add_u32 s44, s52, 4
  s_cmp_ge_u32 s44, 10
  s_cselect_b32 s45, 10, 0
  s_sub_u32 s44, s44, s45
  s_mul_i32 s44, s44, 24576
  s_add_u32 s44, s44, s50
  s_add_u32 s42, s44, 0
  s_add_u32 m0, s51, 0
  s_nop 0
  buffer_load_dwordx4 v13, s[20:23], s42 offen sc1 lds
  s_add_u32 s42, s44, 1024
  s_add_u32 m0, s51, 1024
  s_nop 0
  buffer_load_dwordx4 v13, s[20:23], s42 offen sc1 lds
  s_add_u32 s42, s44, 2048
  s_add_u32 m0, s51, 2048
  s_nop 0
  buffer_load_dwordx4 v13, s[20:23], s42 offen sc1 lds
  s_add_u32 s42, s44, 3072
  s_add_u32 m0, s51, 3072
  s_nop 0
  buffer_load_dwordx4 v13, s[20:23], s42 offen sc1 lds
  s_add_u32 s42, s44, 4096
  s_add_u32 m0, s51, 4096
  s_nop 0
  buffer_load_dwordx4 v13, s[20:23], s42 offen sc1 lds
  s_add_u32 s42, s44, 5120
  s_add_u32 m0, s51, 5120
  s_nop 0
  buffer_load_dwordx4 v13, s[20:23], s42 offen sc1 lds
  s_waitcnt vmcnt(16)
  s_barrier
  s_add_u32 s44, s52, 4
  s_cmp_ge_u32 s44, 10
  s_cselect_b32 s45, 10, 0
  s_sub_u32 s44, s44, s45
  s_lshl_b32 s44, s44, 12
  s_add_u32 s44, s44, s53
  s_add_u32 s42, s44, 0
  s_add_u32 m0, s54, 114688
  s_nop 0
  buffer_load_dwordx4 v13, s[20:23], s42 offen sc1 lds
  s_add_u32 s42, s44, 1024
  s_add_u32 m0, s54, 115712
  s_nop 0
  buffer_load_dwordx4 v13, s[20:23], s42 offen sc1 lds
  s_add_u32 s42, s44, 2048
  s_add_u32 m0, s54, 116736
  s_nop 0
  buffer_load_dwordx4 v13, s[20:23], s42 offen sc1 lds
  s_add_u32 s42, s44, 3072
  s_add_u32 m0, s54, 117760
  s_nop 0
  buffer_load_dwordx4 v13, s[20:23], s42 offen sc1 lds
  s_add_u32 s44, s52, 5
  s_cmp_ge_u32 s44, 10
  s_cselect_b32 s45, 10, 0
  s_sub_u32 s44, s44, s45
  s_mul_i32 s44, s44, 24576
  s_add_u32 s44, s44, s50
  s_add_u32 s42, s44, 0
  s_add_u32 m0, s51, 24576
  s_nop 0
  buffer_load_dwordx4 v13, s[20:23], s42 offen sc1 lds
  s_add_u32 s42, s44, 1024
  s_add_u32 m0, s51, 25600
  s_nop 0
  buffer_load_dwordx4 v13, s[20:23], s42 offen sc1 lds
  s_add_u32 s42, s44, 2048
  s_add_u32 m0, s51, 26624
  s_nop 0
  buffer_load_dwordx4 v13, s[20:23], s42 offen sc1 lds
  s_add_u32 s42, s44, 3072
  s_add_u32 m0, s51, 27648
  s_nop 0
  buffer_load_dwordx4 v13, s[20:23], s42 offen sc1 lds
  s_add_u32 s42, s44, 4096
  s_add_u32 m0, s51, 28672
  s_nop 0
  buffer_load_dwordx4 v13, s[20:23], s42 offen sc1 lds
  s_add_u32 s42, s44, 5120
  s_add_u32 m0, s51, 29696
  s_nop 0
  buffer_load_dwordx4 v13, s[20:23], s42 offen sc1 lds
  s_waitcnt vmcnt(16)
  s_barrier
  s_add_u32 s44, s52, 5
  s_cmp_ge_u32 s44, 10
  s_cselect_b32 s45, 10, 0
  s_sub_u32 s44, s44, s45
  s_lshl_b32 s44, s44, 12
  s_add_u32 s44, s44, s53
  s_add_u32 s42, s44, 0
  s_add_u32 m0, s54, 131072
  s_nop 0
  buffer_load_dwordx4 v13, s[20:23], s42 offen sc1 lds
  s_add_u32 s42, s44, 1024
  s_add_u32 m0, s54, 132096
  s_nop 0
  buffer_load_dwordx4 v13, s[20:23], s42 offen sc1 lds
  s_add_u32 s42, s44, 2048
  s_add_u32 m0, s54, 133120
  s_nop 0
  buffer_load_dwordx4 v13, s[20:23], s42 offen sc1 lds
  s_add_u32 s42, s44, 3072
  s_add_u32 m0, s54, 134144
  s_nop 0
  buffer_load_dwordx4 v13, s[20:23], s42 offen sc1 lds
  s_add_u32 s44, s52, 6
  s_cmp_ge_u32 s44, 10
  s_cselect_b32 s45, 10, 0
  s_sub_u32 s44, s44, s45
  s_mul_i32 s44, s44, 24576
  s_add_u32 s44, s44, s50
  s_add_u32 s42, s44, 0
  s_add_u32 m0, s51, 49152
  s_nop 0
  buffer_load_dwordx4 v13, s[20:23], s42 offen sc1 lds
  s_add_u32 s42, s44, 1024
  s_add_u32 m0, s51, 50176
  s_nop 0
  buffer_load_dwordx4 v13, s[20:23], s42 offen sc1 lds
  s_add_u32 s42, s44, 2048
  s_add_u32 m0, s51, 51200
  s_nop 0
  buffer_load_dwordx4 v13, s[20:23], s42 offen sc1 lds
  s_add_u32 s42, s44, 3072
  s_add_u32 m0, s51, 52224
  s_nop 0
  buffer_load_dwordx4 v13, s[20:23], s42 offen sc1 lds
  s_add_u32 s42, s44, 4096
  s_add_u32 m0, s51, 53248
  s_nop 0
  buffer_load_dwordx4 v13, s[20:23], s42 offen sc1 lds
  s_add_u32 s42, s44, 5120
  s_add_u32 m0, s51, 54272
  s_nop 0
  buffer_load_dwordx4 v13, s[20:23], s42 offen sc1 lds
  s_waitcnt vmcnt(16)
  s_barrier
  s_add_u32 s44, s52, 6
  s_cmp_ge_u32 s44, 10
  s_cselect_b32 s45, 10, 0
  s_sub_u32 s44, s44, s45
  s_lshl_b32 s44, s44, 12
  s_add_u32 s44, s44, s53
  s_add_u32 s42, s44, 0
  s_add_u32 m0, s54, 98304
  s_nop 0
  buffer_load_dwordx4 v13, s[20:23], s42 offen sc1 lds
  s_add_u32 s42, s44, 1024
  s_add_u32 m0, s54, 99328
  s_nop 0
  buffer_load_dwordx4 v13, s[20:23], s42 offen sc1 lds
  s_add_u32 s42, s44, 2048
  s_add_u32 m0, s54, 100352
  s_nop 0
  buffer_load_dwordx4 v13, s[20:23], s42 offen sc1 lds
  s_add_u32 s42, s44, 3072
  s_add_u32 m0, s54, 101376
  s_nop 0
  buffer_load_dwordx4 v13, s[20:23], s42 offen sc1 lds
  s_add_u32 s44, s52, 7
  s_cmp_ge_u32 s44, 10
  s_cselect_b32 s45, 10, 0
  s_sub_u32 s44, s44, s45
  s_mul_i32 s44, s44, 24576
  s_add_u32 s44, s44, s50
  s_add_u32 s42, s44, 0
  s_add_u32 m0, s51, 73728
  s_nop 0
  buffer_load_dwordx4 v13, s[20:23], s42 offen sc1 lds
  s_add_u32 s42, s44, 1024
  s_add_u32 m0, s51, 74752
  s_nop 0
  buffer_load_dwordx4 v13, s[20:23], s42 offen sc1 lds
  s_add_u32 s42, s44, 2048
  s_add_u32 m0, s51, 75776
  s_nop 0
  buffer_load_dwordx4 v13, s[20:23], s42 offen sc1 lds
  s_add_u32 s42, s44, 3072
  s_add_u32 m0, s51, 76800
  s_nop 0
  buffer_load_dwordx4 v13, s[20:23], s42 offen sc1 lds
  s_add_u32 s42, s44, 4096
  s_add_u32 m0, s51, 77824
  s_nop 0
  buffer_load_dwordx4 v13, s[20:23], s42 offen sc1 lds
  s_add_u32 s42, s44, 5120
  s_add_u32 m0, s51, 78848
  s_nop 0
  buffer_load_dwordx4 v13, s[20:23], s42 offen sc1 lds
  s_waitcnt vmcnt(16)
  s_barrier
  s_add_u32 s44, s52, 7
  s_cmp_ge_u32 s44, 10
  s_cselect_b32 s45, 10, 0
  s_sub_u32 s44, s44, s45
  s_lshl_b32 s44, s44, 12
  s_add_u32 s44, s44, s53
  s_add_u32 s42, s44, 0
  s_add_u32 m0, s54, 114688
  s_nop 0
  buffer_load_dwordx4 v13, s[20:23], s42 offen sc1 lds
  s_add_u32 s42, s44, 1024
  s_add_u32 m0, s54, 115712
  s_nop 0
  buffer_load_dwordx4 v13, s[20:23], s42 offen sc1 lds
  s_add_u32 s42, s44, 2048
  s_add_u32 m0, s54, 116736
  s_nop 0
  buffer_load_dwordx4 v13, s[20:23], s42 offen sc1 lds
  s_add_u32 s42, s44, 3072
  s_add_u32 m0, s54, 117760
  s_nop 0
  buffer_load_dwordx4 v13, s[20:23], s42 offen sc1 lds
  s_add_u32 s44, s52, 8
  s_cmp_ge_u32 s44, 10
  s_cselect_b32 s45, 10, 0
  s_sub_u32 s44, s44, s45
  s_mul_i32 s44, s44, 24576
  s_add_u32 s44, s44, s50
  s_add_u32 s42, s44, 0
  s_add_u32 m0, s51, 0
  s_nop 0
  buffer_load_dwordx4 v13, s[20:23], s42 offen sc1 lds
  s_add_u32 s42, s44, 1024
  s_add_u32 m0, s51, 1024
  s_nop 0
  buffer_load_dwordx4 v13, s[20:23], s42 offen sc1 lds
  s_add_u32 s42, s44, 2048
  s_add_u32 m0, s51, 2048
  s_nop 0
  buffer_load_dwordx4 v13, s[20:23], s42 offen sc1 lds
  s_add_u32 s42, s44, 3072
  s_add_u32 m0, s51, 3072
  s_nop 0
  buffer_load_dwordx4 v13, s[20:23], s42 offen sc1 lds
  s_add_u32 s42, s44, 4096
  s_add_u32 m0, s51, 4096
  s_nop 0
  buffer_load_dwordx4 v13, s[20:23], s42 offen sc1 lds
  s_add_u32 s42, s44, 5120
  s_add_u32 m0, s51, 5120
  s_nop 0
  buffer_load_dwordx4 v13, s[20:23], s42 offen sc1 lds
  s_waitcnt vmcnt(16)
  s_barrier
  s_add_u32 s44, s52, 8
  s_cmp_ge_u32 s44, 10
  s_cselect_b32 s45, 10, 0
  s_sub_u32 s44, s44, s45
  s_lshl_b32 s44, s44, 12
  s_add_u32 s44, s44, s53
  s_add_u32 s42, s44, 0
  s_add_u32 m0, s54, 131072
  s_nop 0
  buffer_load_dwordx4 v13, s[20:23], s42 offen sc1 lds
  s_add_u32 s42, s44, 1024
  s_add_u32 m0, s54, 132096
  s_nop 0
  buffer_load_dwordx4 v13, s[20:23], s42 offen sc1 lds
  s_add_u32 s42, s44, 2048
  s_add_u32 m0, s54, 133120
  s_nop 0
  buffer_load_dwordx4 v13, s[20:23], s42 offen sc1 lds
  s_add_u32 s42, s44, 3072
  s_add_u32 m0, s54, 134144
  s_nop 0
  buffer_load_dwordx4 v13, s[20:23], s42 offen sc1 lds
  s_add_u32 s44, s52, 9
  s_cmp_ge_u32 s44, 10
  s_cselect_b32 s45, 10, 0
  s_sub_u32 s44, s44, s45
  s_mul_i32 s44, s44, 24576
  s_add_u32 s44, s44, s50
  s_add_u32 s42, s44, 0
  s_add_u32 m0, s51, 24576
  s_nop 0
  buffer_load_dwordx4 v13, s[20:23], s42 offen sc1 lds
  s_add_u32 s42, s44, 1024
  s_add_u32 m0, s51, 25600
  s_nop 0
  buffer_load_dwordx4 v13, s[20:23], s42 offen sc1 lds
  s_add_u32 s42, s44, 2048
  s_add_u32 m0, s51, 26624
  s_nop 0
  buffer_load_dwordx4 v13, s[20:23], s42 offen sc1 lds
  s_add_u32 s42, s44, 3072
  s_add_u32 m0, s51, 27648
  s_nop 0
  buffer_load_dwordx4 v13, s[20:23], s42 offen sc1 lds
  s_add_u32 s42, s44, 4096
  s_add_u32 m0, s51, 28672
  s_nop 0
  buffer_load_dwordx4 v13, s[20:23], s42 offen sc1 lds
  s_add_u32 s42, s44, 5120
  s_add_u32 m0, s51, 29696
  s_nop 0
  buffer_load_dwordx4 v13, s[20:23], s42 offen sc1 lds
  s_waitcnt vmcnt(16)
  s_barrier
  s_add_u32 s44, s52, 9
  s_cmp_ge_u32 s44, 10
  s_cselect_b32 s45, 10, 0
  s_sub_u32 s44, s44, s45
  s_lshl_b32 s44, s44, 12
  s_add_u32 s44, s44, s53
  s_add_u32 s42, s44, 0
  s_add_u32 m0, s54, 98304
  s_nop 0
  buffer_load_dwordx4 v13, s[20:23], s42 offen sc1 lds
  s_add_u32 s42, s44, 1024
  s_add_u32 m0, s54, 99328
  s_nop 0
  buffer_load_dwordx4 v13, s[20:23], s42 offen sc1 lds
  s_add_u32 s42, s44, 2048
  s_add_u32 m0, s54, 100352
  s_nop 0
  buffer_load_dwordx4 v13, s[20:23], s42 offen sc1 lds
  s_add_u32 s42, s44, 3072
  s_add_u32 m0, s54, 101376
  s_nop 0
  buffer_load_dwordx4 v13, s[20:23], s42 offen sc1 lds
  s_mul_i32 s34, s26, 48
  v_add_u32 v2, s34, v1
  v_mul_u32_u24 v3, 2731, v2
  v_lshrrev_b32 v3, 16, v3
  v_mul_u32_u24 v4, 24, v3
  v_sub_u32 v4, v2, v4
  v_mul_u32_u24 v3, 49152, v3
  v_lshl_add_u32 v5, v4, 7, v3
  s_lshl_b32 s34, s4, 3
  s_mul_i32 s34, s34, 48
  s_mul_i32 s35, s5, 3
  s_add_u32 s34, s34, s35
  s_lshl_b32 s34, s34, 10
  s_add_u32 s34, s34, 14680064
  s_mov_b32 exec_lo, -1
  s_mov_b32 exec_hi, 0xffff
  buffer_load_dword v250, v5, s[20:23], s34 offen
  s_mov_b64 exec, -1
  s_waitcnt vmcnt(11)
  s_barrier
  s_waitcnt vmcnt(1)
  s_barrier
  s_barrier
  v_lshlrev_b32 v13, 4, v1
  s_mul_i32 s38, s26, 5120
  s_mul_i32 s35, s24, 245760
  s_add_u32 s35, s35, s38
  s_add_u32 s35, s35, 29360128
  s_lshl_b32 s36, s4, 3
  s_lshl_b32 s37, s7, 2
  s_add_u32 s36, s36, s37
  s_add_u32 s36, s36, s26
  s_mul_i32 s36, s36, 49152
  s_add_u32 s36, s36, 14680064
  s_lshl_b32 s37, s26, 12
  s_and_b32 s52, s2, 7
  s_mul_i32 s52, s52, 3
  s_lshr_b32 s52, s52, 1
  s_add_u32 s44, s52, 0
  s_cmp_ge_u32 s44, 12
  s_cselect_b32 s45, 12, 0
  s_sub_u32 s44, s44, s45
  s_mul_i32 s44, s44, 20480
  s_add_u32 s44, s44, s35
  s_add_u32 s42, s44, 0
  s_add_u32 m0, s38, 0
  s_nop 0
  buffer_load_dwordx4 v13, s[20:23], s42 offen sc1 lds
  s_add_u32 s42, s44, 1024
  s_add_u32 m0, s38, 1024
  s_nop 0
  buffer_load_dwordx4 v13, s[20:23], s42 offen sc1 lds
  s_add_u32 s42, s44, 2048
  s_add_u32 m0, s38, 2048
  s_nop 0
  buffer_load_dwordx4 v13, s[20:23], s42 offen sc1 lds
  s_add_u32 s42, s44, 3072
  s_add_u32 m0, s38, 3072
  s_nop 0
  buffer_load_dwordx4 v13, s[20:23], s42 offen sc1 lds
  s_add_u32 s42, s44, 4096
  s_add_u32 m0, s38, 4096
  s_nop 0
  buffer_load_dwordx4 v13, s[20:23], s42 offen sc1 lds
  s_add_u32 s44, s52, 1
  s_cmp_ge_u32 s44, 12
  s_cselect_b32 s45, 12, 0
  s_sub_u32 s44, s44, s45
  s_mul_i32 s44, s44, 20480
  s_add_u32 s44, s44, s35
  s_add_u32 s42, s44, 0
  s_add_u32 m0, s38, 20480
  s_nop 0
  buffer_load_dwordx4 v13, s[20:23], s42 offen sc1 lds
  s_add_u32 s42, s44, 1024
  s_add_u32 m0, s38, 21504
  s_nop 0
  buffer_load_dwordx4 v13, s[20:23], s42 offen sc1 lds
  s_add_u32 s42, s44, 2048
  s_add_u32 m0, s38, 22528
  s_nop 0
  buffer_load_dwordx4 v13, s[20:23], s42 offen sc1 lds
  s_add_u32 s42, s44, 3072
  s_add_u32 m0, s38, 23552
  s_nop 0
  buffer_load_dwordx4 v13, s[20:23], s42 offen sc1 lds
  s_add_u32 s42, s44, 4096
  s_add_u32 m0, s38, 24576
  s_nop 0
  buffer_load_dwordx4 v13, s[20:23], s42 offen sc1 lds
  s_add_u32 s44, s52, 2
  s_cmp_ge_u32 s44, 12
  s_cselect_b32 s45, 12, 0
  s_sub_u32 s44, s44, s45
  s_mul_i32 s44, s44, 20480
  s_add_u32 s44, s44, s35
  s_add_u32 s42, s44, 0
  s_add_u32 m0, s38, 40960
  s_nop 0
  buffer_load_dwordx4 v13, s[20:23], s42 offen sc1 lds
  s_add_u32 s42, s44, 1024
  s_add_u32 m0, s38, 41984
  s_nop 0
  buffer_load_dwordx4 v13, s[20:23], s42 offen sc1 lds
  s_add_u32 s42, s44, 2048
  s_add_u32 m0, s38, 43008
  s_nop 0
  buffer_load_dwordx4 v13, s[20:23], s42 offen sc1 lds
  s_add_u32 s42, s44, 3072
  s_add_u32 m0, s38, 44032
  s_nop 0
  buffer_load_dwordx4 v13, s[20:23], s42 offen sc1 lds
  s_add_u32 s42, s44, 4096
  s_add_u32 m0, s38, 45056
  s_nop 0
  buffer_load_dwordx4 v13, s[20:23], s42 offen sc1 lds
  s_add_u32 s44, s52, 3
  s_cmp_ge_u32 s44, 12
  s_cselect_b32 s45, 12, 0
  s_sub_u32 s44, s44, s45
  s_mul_i32 s44, s44, 20480
  s_add_u32 s44, s44, s35
  s_add_u32 s42, s44, 0
  s_add_u32 m0, s38, 61440
  s_nop 0
  buffer_load_dwordx4 v13, s[20:23], s42 offen sc1 lds
  s_add_u32 s42, s44, 1024
  s_add_u32 m0, s38, 62464
  s_nop 0
  buffer_load_dwordx4 v13, s[20:23], s42 offen sc1 lds
  s_add_u32 s42, s44, 2048
  s_add_u32 m0, s38, 63488
  s_nop 0
  buffer_load_dwordx4 v13, s[20:23], s42 offen sc1 lds
  s_add_u32 s42, s44, 3072
  s_add_u32 m0, s38, 64512
  s_nop 0
  buffer_load_dwordx4 v13, s[20:23], s42 offen sc1 lds
  s_add_u32 s42, s44, 4096
  s_add_u32 m0, s38, 65536
  s_nop 0
  buffer_load_dwordx4 v13, s[20:23], s42 offen sc1 lds
  s_add_u32 s44, s52, 4
  s_cmp_ge_u32 s44, 12
  s_cselect_b32 s45, 12, 0
  s_sub_u32 s44, s44, s45
  s_mul_i32 s44, s44, 20480
  s_add_u32 s44, s44, s35
  s_add_u32 s42, s44, 0
  s_add_u32 m0, s38, 81920
  s_nop 0
  buffer_load_dwordx4 v13, s[20:23], s42 offen sc1 lds
  s_add_u32 s42, s44, 1024
  s_add_u32 m0, s38, 82944
  s_nop 0
  buffer_load_dwordx4 v13, s[20:23], s42 offen sc1 lds
  s_add_u32 s42, s44, 2048
  s_add_u32 m0, s38, 83968
  s_nop 0
  buffer_load_dwordx4 v13, s[20:23], s42 offen sc1 lds
  s_add_u32 s42, s44, 3072
  s_add_u32 m0, s38, 84992
  s_nop 0
  buffer_load_dwordx4 v13, s[20:23], s42 offen sc1 lds
  s_add_u32 s42, s44, 4096
  s_add_u32 m0, s38, 86016
  s_nop 0
  buffer_load_dwordx4 v13, s[20:23], s42 offen sc1 lds
  s_barrier
  s_barrier
  s_add_u32 s44, s52, 0
  s_cmp_ge_u32 s44, 12
  s_cselect_b32 s45, 12, 0
  s_sub_u32 s44, s44, s45
  s_lshl_b32 s44, s44, 12
  s_add_u32 s44, s44, s36
  s_add_u32 s42, s44, 0
  s_add_u32 m0, s37, 102400
  s_nop 0
  buffer_load_dwordx4 v13, s[20:23], s42 offen sc1 lds
  s_add_u32 s42, s44, 1024
  s_add_u32 m0, s37, 103424
  s_nop 0
  buffer_load_dwordx4 v13, s[20:23], s42 offen sc1 lds
  s_add_u32 s42, s44, 2048
  s_add_u32 m0, s37, 104448
  s_nop 0
  buffer_load_dwordx4 v13, s[20:23], s42 offen sc1 lds
  s_add_u32 s42, s44, 3072
  s_add_u32 m0, s37, 105472
  s_nop 0
  buffer_load_dwordx4 v13, s[20:23], s42 offen sc1 lds
  s_add_u32 s44, s52, 1
  s_cmp_ge_u32 s44, 12
  s_cselect_b32 s45, 12, 0
  s_sub_u32 s44, s44, s45
  s_lshl_b32 s44, s44, 12
  s_add_u32 s44, s44, s36
  s_add_u32 s42, s44, 0
  s_add_u32 m0, s37, 118784
  s_nop 0
  buffer_load_dwordx4 v13, s[20:23], s42 offen sc1 lds
  s_add_u32 s42, s44, 1024
  s_add_u32 m0, s37, 119808
  s_nop 0
  buffer_load_dwordx4 v13, s[20:23], s42 offen sc1 lds
  s_add_u32 s42, s44, 2048
  s_add_u32 m0, s37, 120832
  s_nop 0
  buffer_load_dwordx4 v13, s[20:23], s42 offen sc1 lds
  s_add_u32 s42, s44, 3072
  s_add_u32 m0, s37, 121856
  s_nop 0
  buffer_load_dwordx4 v13, s[20:23], s42 offen sc1 lds
  s_waitcnt vmcnt(4)
  s_barrier
  s_add_u32 s44, s52, 2
  s_cmp_ge_u32 s44, 12
  s_cselect_b32 s45, 12, 0
  s_sub_u32 s44, s44, s45
  s_lshl_b32 s44, s44, 12
  s_add_u32 s44, s44, s36
  s_add_u32 s42, s44, 0
  s_add_u32 m0, s37, 135168
  s_nop 0
  buffer_load_dwordx4 v13, s[20:23], s42 offen sc1 lds
  s_add_u32 s42, s44, 1024
  s_add_u32 m0, s37, 136192
  s_nop 0
  buffer_load_dwordx4 v13, s[20:23], s42 offen sc1 lds
  s_add_u32 s42, s44, 2048
  s_add_u32 m0, s37, 137216
  s_nop 0
  buffer_load_dwordx4 v13, s[20:23], s42 offen sc1 lds
  s_add_u32 s42, s44, 3072
  s_add_u32 m0, s37, 138240
  s_nop 0
  buffer_load_dwordx4 v13, s[20:23], s42 offen sc1 lds
  s_waitcnt vmcnt(4)
  s_barrier
  s_add_u32 s44, s52, 3
  s_cmp_ge_u32 s44, 12
  s_cselect_b32 s45, 12, 0
  s_sub_u32 s44, s44, s45
  s_lshl_b32 s44, s44, 12
  s_add_u32 s44, s44, s36
  s_add_u32 s42, s44, 0
  s_add_u32 m0, s37, 102400
  s_nop 0
  buffer_load_dwordx4 v13, s[20:23], s42 offen sc1 lds
  s_add_u32 s42, s44, 1024
  s_add_u32 m0, s37, 103424
  s_nop 0
  buffer_load_dwordx4 v13, s[20:23], s42 offen sc1 lds
  s_add_u32 s42, s44, 2048
  s_add_u32 m0, s37, 104448
  s_nop 0
  buffer_load_dwordx4 v13, s[20:23], s42 offen sc1 lds
  s_add_u32 s42, s44, 3072
  s_add_u32 m0, s37, 105472
  s_nop 0
  buffer_load_dwordx4 v13, s[20:23], s42 offen sc1 lds
  s_add_u32 s44, s52, 5
  s_cmp_ge_u32 s44, 12
  s_cselect_b32 s45, 12, 0
  s_sub_u32 s44, s44, s45
  s_mul_i32 s44, s44, 20480
  s_add_u32 s44, s44, s35
  s_add_u32 s42, s44, 0
  s_add_u32 m0, s38, 0
  s_nop 0
  buffer_load_dwordx4 v13, s[20:23], s42 offen sc1 lds
  s_add_u32 s42, s44, 1024
  s_add_u32 m0, s38, 1024
  s_nop 0
  buffer_load_dwordx4 v13, s[20:23], s42 offen sc1 lds
  s_add_u32 s42, s44, 2048
  s_add_u32 m0, s38, 2048
  s_nop 0
  buffer_load_dwordx4 v13, s[20:23], s42 offen sc1 lds
  s_add_u32 s42, s44, 3072
  s_add_u32 m0, s38, 3072
  s_nop 0
  buffer_load_dwordx4 v13, s[20:23], s42 offen sc1 lds
  s_add_u32 s42, s44, 4096
  s_add_u32 m0, s38, 4096
  s_nop 0
  buffer_load_dwordx4 v13, s[20:23], s42 offen sc1 lds
  s_waitcnt vmcnt(9)
  s_barrier
  s_add_u32 s44, s52, 4
  s_cmp_ge_u32 s44, 12
  s_cselect_b32 s45, 12, 0
  s_sub_u32 s44, s44, s45
  s_lshl_b32 s44, s44, 12
  s_add_u32 s44, s44, s36
  s_add_u32 s42, s44, 0
  s_add_u32 m0, s37, 118784
  s_nop 0
  buffer_load_dwordx4 v13, s[20:23], s42 offen sc1 lds
  s_add_u32 s42, s44, 1024
  s_add_u32 m0, s37, 119808
  s_nop 0
  buffer_load_dwordx4 v13, s[20:23], s42 offen sc1 lds
  s_add_u32 s42, s44, 2048
  s_add_u32 m0, s37, 120832
  s_nop 0
  buffer_load_dwordx4 v13, s[20:23], s42 offen sc1 lds
  s_add_u32 s42, s44, 3072
  s_add_u32 m0, s37, 121856
  s_nop 0
  buffer_load_dwordx4 v13, s[20:23], s42 offen sc1 lds
  s_add_u32 s44, s52, 6
  s_cmp_ge_u32 s44, 12
  s_cselect_b32 s45, 12, 0
  s_sub_u32 s44, s44, s45
  s_mul_i32 s44, s44, 20480
  s_add_u32 s44, s44, s35
  s_add_u32 s42, s44, 0
  s_add_u32 m0, s38, 20480
  s_nop 0
  buffer_load_dwordx4 v13, s[20:23], s42 offen sc1 lds
  s_add_u32 s42, s44, 1024
  s_add_u32 m0, s38, 21504
  s_nop 0
  buffer_load_dwordx4 v13, s[20:23], s42 offen sc1 lds
  s_add_u32 s42, s44, 2048
  s_add_u32 m0, s38, 22528
  s_nop 0
  buffer_load_dwordx4 v13, s[20:23], s42 offen sc1 lds
  s_add_u32 s42, s44, 3072
  s_add_u32 m0, s38, 23552
  s_nop 0
  buffer_load_dwordx4 v13, s[20:23], s42 offen sc1 lds
  s_add_u32 s42, s44, 4096
  s_add_u32 m0, s38, 24576
  s_nop 0
  buffer_load_dwordx4 v13, s[20:23], s42 offen sc1 lds
  s_waitcnt vmcnt(14)
  s_barrier
  s_add_u32 s44, s52, 5
  s_cmp_ge_u32 s44, 12
  s_cselect_b32 s45, 12, 0
  s_sub_u32 s44, s44, s45
  s_lshl_b32 s44, s44, 12
  s_add_u32 s44, s44, s36
  s_add_u32 s42, s44, 0
  s_add_u32 m0, s37, 135168
  s_nop 0
  buffer_load_dwordx4 v13, s[20:23], s42 offen sc1 lds
  s_add_u32 s42, s44, 1024
  s_add_u32 m0, s37, 136192
  s_nop 0
  buffer_load_dwordx4 v13, s[20:23], s42 offen sc1 lds
  s_add_u32 s42, s44, 2048
  s_add_u32 m0, s37, 137216
  s_nop 0
  buffer_load_dwordx4 v13, s[20:23], s42 offen sc1 lds
  s_add_u32 s42, s44, 3072
  s_add_u32 m0, s37, 138240
  s_nop 0
  buffer_load_dwordx4 v13, s[20:23], s42 offen sc1 lds
  s_add_u32 s44, s52, 7
  s_cmp_ge_u32 s44, 12
  s_cselect_b32 s45, 12, 0
  s_sub_u32 s44, s44, s45
  s_mul_i32 s44, s44, 20480
  s_add_u32 s44, s44, s35
  s_add_u32 s42, s44, 0
  s_add_u32 m0, s38, 40960
  s_nop 0
  buffer_load_dwordx4 v13, s[20:23], s42 offen sc1 lds
  s_add_u32 s42, s44, 1024
  s_add_u32 m0, s38, 41984
  s_nop 0
  buffer_load_dwordx4 v13, s[20:23], s42 offen sc1 lds
  s_add_u32 s42, s44, 2048
  s_add_u32 m0, s38, 43008
  s_nop 0
  buffer_load_dwordx4 v13, s[20:23], s42 offen sc1 lds
  s_add_u32 s42, s44, 3072
  s_add_u32 m0, s38, 44032
  s_nop 0
  buffer_load_dwordx4 v13, s[20:23], s42 offen sc1 lds
  s_add_u32 s42, s44, 4096
  s_add_u32 m0, s38, 45056
  s_nop 0
  buffer_load_dwordx4 v13, s[20:23], s42 offen sc1 lds
  s_waitcnt vmcnt(14)
  s_barrier
  s_add_u32 s44, s52, 6
  s_cmp_ge_u32 s44, 12
  s_cselect_b32 s45, 12, 0
  s_sub_u32 s44, s44, s45
  s_lshl_b32 s44, s44, 12
  s_add_u32 s44, s44, s36
  s_add_u32 s42, s44, 0
  s_add_u32 m0, s37, 102400
  s_nop 0
  buffer_load_dwordx4 v13, s[20:23], s42 offen sc1 lds
  s_add_u32 s42, s44, 1024
  s_add_u32 m0, s37, 103424
  s_nop 0
  buffer_load_dwordx4 v13, s[20:23], s42 offen sc1 lds
  s_add_u32 s42, s44, 2048
  s_add_u32 m0, s37, 104448
  s_nop 0
  buffer_load_dwordx4 v13, s[20:23], s42 offen sc1 lds
  s_add_u32 s42, s44, 3072
  s_add_u32 m0, s37, 105472
  s_nop 0
  buffer_load_dwordx4 v13, s[20:23], s42 offen sc1 lds
  s_add_u32 s44, s52, 8
  s_cmp_ge_u32 s44, 12
  s_cselect_b32 s45, 12, 0
  s_sub_u32 s44, s44, s45
  s_mul_i32 s44, s44, 20480
  s_add_u32 s44, s44, s35
  s_add_u32 s42, s44, 0
  s_add_u32 m0, s38, 61440
  s_nop 0
  buffer_load_dwordx4 v13, s[20:23], s42 offen sc1 lds
  s_add_u32 s42, s44, 1024
  s_add_u32 m0, s38, 62464
  s_nop 0
  buffer_load_dwordx4 v13, s[20:23], s42 offen sc1 lds
  s_add_u32 s42, s44, 2048
  s_add_u32 m0, s38, 63488
  s_nop 0
  buffer_load_dwordx4 v13, s[20:23], s42 offen sc1 lds
  s_add_u32 s42, s44, 3072
  s_add_u32 m0, s38, 64512
  s_nop 0
  buffer_load_dwordx4 v13, s[20:23], s42 offen sc1 lds
  s_add_u32 s42, s44, 4096
  s_add_u32 m0, s38, 65536
  s_nop 0
  buffer_load_dwordx4 v13, s[20:23], s42 offen sc1 lds
  s_waitcnt vmcnt(14)
  s_barrier
  s_add_u32 s44, s52, 7
  s_cmp_ge_u32 s44, 12
  s_cselect_b32 s45, 12, 0
  s_sub_u32 s44, s44, s45
  s_lshl_b32 s44, s44, 12
  s_add_u32 s44, s44, s36
  s_add_u32 s42, s44, 0
  s_add_u32 m0, s37, 118784
  s_nop 0
  buffer_load_dwordx4 v13, s[20:23], s42 offen sc1 lds
  s_add_u32 s42, s44, 1024
  s_add_u32 m0, s37, 119808
  s_nop 0
  buffer_load_dwordx4 v13, s[20:23], s42 offen sc1 lds
  s_add_u32 s42, s44, 2048
  s_add_u32 m0, s37, 120832
  s_nop 0
  buffer_load_dwordx4 v13, s[20:23], s42 offen sc1 lds
  s_add_u32 s42, s44, 3072
  s_add_u32 m0, s37, 121856
  s_nop 0
  buffer_load_dwordx4 v13, s[20:23], s42 offen sc1 lds
  s_add_u32 s44, s52, 9
  s_cmp_ge_u32 s44, 12
  s_cselect_b32 s45, 12, 0
  s_sub_u32 s44, s44, s45
  s_mul_i32 s44, s44, 20480
  s_add_u32 s44, s44, s35
  s_add_u32 s42, s44, 0
  s_add_u32 m0, s38, 81920
  s_nop 0
  buffer_load_dwordx4 v13, s[20:23], s42 offen sc1 lds
  s_add_u32 s42, s44, 1024
  s_add_u32 m0, s38, 82944
  s_nop 0
  buffer_load_dwordx4 v13, s[20:23], s42 offen sc1 lds
  s_add_u32 s42, s44, 2048
  s_add_u32 m0, s38, 83968
  s_nop 0
  buffer_load_dwordx4 v13, s[20:23], s42 offen sc1 lds
  s_add_u32 s42, s44, 3072
  s_add_u32 m0, s38, 84992
  s_nop 0
  buffer_load_dwordx4 v13, s[20:23], s42 offen sc1 lds
  s_add_u32 s42, s44, 4096
  s_add_u32 m0, s38, 86016
  s_nop 0
  buffer_load_dwordx4 v13, s[20:23], s42 offen sc1 lds
  s_waitcnt vmcnt(14)
  s_barrier
  s_add_u32 s44, s52, 8
  s_cmp_ge_u32 s44, 12
  s_cselect_b32 s45, 12, 0
  s_sub_u32 s44, s44, s45
  s_lshl_b32 s44, s44, 12
  s_add_u32 s44, s44, s36
  s_add_u32 s42, s44, 0
  s_add_u32 m0, s37, 135168
  s_nop 0
  buffer_load_dwordx4 v13, s[20:23], s42 offen sc1 lds
  s_add_u32 s42, s44, 1024
  s_add_u32 m0, s37, 136192
  s_nop 0
  buffer_load_dwordx4 v13, s[20:23], s42 offen sc1 lds
  s_add_u32 s42, s44, 2048
  s_add_u32 m0, s37, 137216
  s_nop 0
  buffer_load_dwordx4 v13, s[20:23], s42 offen sc1 lds
  s_add_u32 s42, s44, 3072
  s_add_u32 m0, s37, 138240
  s_nop 0
  buffer_load_dwordx4 v13, s[20:23], s42 offen sc1 lds
  s_add_u32 s44, s52, 10
  s_cmp_ge_u32 s44, 12
  s_cselect_b32 s45, 12, 0
  s_sub_u32 s44, s44, s45
  s_mul_i32 s44, s44, 20480
  s_add_u32 s44, s44, s35
  s_add_u32 s42, s44, 0
  s_add_u32 m0, s38, 0
  s_nop 0
  buffer_load_dwordx4 v13, s[20:23], s42 offen sc1 lds
  s_add_u32 s42, s44, 1024
  s_add_u32 m0, s38, 1024
  s_nop 0
  buffer_load_dwordx4 v13, s[20:23], s42 offen sc1 lds
  s_add_u32 s42, s44, 2048
  s_add_u32 m0, s38, 2048
  s_nop 0
  buffer_load_dwordx4 v13, s[20:23], s42 offen sc1 lds
  s_add_u32 s42, s44, 3072
  s_add_u32 m0, s38, 3072
  s_nop 0
  buffer_load_dwordx4 v13, s[20:23], s42 offen sc1 lds
  s_add_u32 s42, s44, 4096
  s_add_u32 m0, s38, 4096
  s_nop 0
  buffer_load_dwordx4 v13, s[20:23], s42 offen sc1 lds
  s_waitcnt vmcnt(14)
  s_barrier
  s_add_u32 s44, s52, 9
  s_cmp_ge_u32 s44, 12
  s_cselect_b32 s45, 12, 0
  s_sub_u32 s44, s44, s45
  s_lshl_b32 s44, s44, 12
  s_add_u32 s44, s44, s36
  s_add_u32 s42, s44, 0
  s_add_u32 m0, s37, 102400
  s_nop 0
  buffer_load_dwordx4 v13, s[20:23], s42 offen sc1 lds
  s_add_u32 s42, s44, 1024
  s_add_u32 m0, s37, 103424
  s_nop 0
  buffer_load_dwordx4 v13, s[20:23], s42 offen sc1 lds
  s_add_u32 s42, s44, 2048
  s_add_u32 m0, s37, 104448
  s_nop 0
  buffer_load_dwordx4 v13, s[20:23], s42 offen sc1 lds
  s_add_u32 s42, s44, 3072
  s_add_u32 m0, s37, 105472
  s_nop 0
  buffer_load_dwordx4 v13, s[20:23], s42 offen sc1 lds
  s_add_u32 s44, s52, 11
  s_cmp_ge_u32 s44, 12
  s_cselect_b32 s45, 12, 0
  s_sub_u32 s44, s44, s45
  s_mul_i32 s44, s44, 20480
  s_add_u32 s44, s44, s35
  s_add_u32 s42, s44, 0
  s_add_u32 m0, s38, 20480
  s_nop 0
  buffer_load_dwordx4 v13, s[20:23], s42 offen sc1 lds
  s_add_u32 s42, s44, 1024
  s_add_u32 m0, s38, 21504
  s_nop 0
  buffer_load_dwordx4 v13, s[20:23], s42 offen sc1 lds
  s_add_u32 s42, s44, 2048
  s_add_u32 m0, s38, 22528
  s_nop 0
  buffer_load_dwordx4 v13, s[20:23], s42 offen sc1 lds
  s_add_u32 s42, s44, 3072
  s_add_u32 m0, s38, 23552
  s_nop 0
  buffer_load_dwordx4 v13, s[20:23], s42 offen sc1 lds
  s_add_u32 s42, s44, 4096
  s_add_u32 m0, s38, 24576
  s_nop 0
  buffer_load_dwordx4 v13, s[20:23], s42 offen sc1 lds
  s_waitcnt vmcnt(14)
  s_barrier
  s_add_u32 s44, s52, 10
  s_cmp_ge_u32 s44, 12
  s_cselect_b32 s45, 12, 0
  s_sub_u32 s44, s44, s45
  s_lshl_b32 s44, s44, 12
  s_add_u32 s44, s44, s36
  s_add_u32 s42, s44, 0
  s_add_u32 m0, s37, 118784
  s_nop 0
  buffer_load_dwordx4 v13, s[20:23], s42 offen sc1 lds
  s_add_u32 s42, s44, 1024
  s_add_u32 m0, s37, 119808
  s_nop 0
  buffer_load_dwordx4 v13, s[20:23], s42 offen sc1 lds
  s_add_u32 s42, s44, 2048
  s_add_u32 m0, s37, 120832
  s_nop 0
  buffer_load_dwordx4 v13, s[20:23], s42 offen sc1 lds
  s_add_u32 s42, s44, 3072
  s_add_u32 m0, s37, 121856
  s_nop 0
  buffer_load_dwordx4 v13, s[20:23], s42 offen sc1 lds
  s_waitcnt vmcnt(9)
  s_barrier
  s_add_u32 s44, s52, 11
  s_cmp_ge_u32 s44, 12
  s_cselect_b32 s45, 12, 0
  s_sub_u32 s44, s44, s45
  s_lshl_b32 s44, s44, 12
  s_add_u32 s44, s44, s36
  s_add_u32 s42, s44, 0
  s_add_u32 m0, s37, 135168
  s_nop 0
  buffer_load_dwordx4 v13, s[20:23], s42 offen sc1 lds
  s_add_u32 s42, s44, 1024
  s_add_u32 m0, s37, 136192
  s_nop 0
  buffer_load_dwordx4 v13, s[20:23], s42 offen sc1 lds
  s_add_u32 s42, s44, 2048
  s_add_u32 m0, s37, 137216
  s_nop 0
  buffer_load_dwordx4 v13, s[20:23], s42 offen sc1 lds
  s_add_u32 s42, s44, 3072
  s_add_u32 m0, s37, 138240
  s_nop 0
  buffer_load_dwordx4 v13, s[20:23], s42 offen sc1 lds
  s_waitcnt vmcnt(4)
  s_barrier
  s_waitcnt vmcnt(0)
  s_barrier
  s_barrier
sequential_preLN__linear_kernel_hedgehog__glu_gated_reglu__prompt_kernel_fin:
  s_barrier
  s_mov_b32 s16, s76
  s_mov_b32 s17, s77
  s_mov_b32 s18, 0x280000
  s_mov_b32 s19, 0x20000
  s_lshl_b32 s34, s4, 7
  s_lshl_b32 s35, s7, 6
  s_add_u32 s34, s34, s35
  s_mul_i32 s34, s34, 1280
  s_mul_i32 s35, s24, 160
  s_add_u32 s34, s34, s35
  s_lshl_b32 s35, s3, 6
  s_add_u32 s35, s35, 0
  v_add_u32 v2, s35, v1
  v_mul_u32_u24 v3, 6554, v2
  v_lshrrev_b32 v3, 16, v3
  v_mul_u32_u24 v4, 10, v3
  v_sub_u32 v4, v2, v4
  v_mul_u32_u24 v3, 1280, v3
  v_lshl_add_u32 v3, v4, 4, v3
  v_lshlrev_b32 v2, 4, v2
  v_add_u32 v2, 153600, v2
  ds_read_b128 v[8:11], v2
  s_waitcnt lgkmcnt(0)
  buffer_store_dwordx4 v[8:11], v3, s[16:19], s34 offen
  s_cmp_ge_u32 s3, 2
  s_cbranch_scc1 Lfe_80
  s_lshl_b32 s35, s3, 6
  s_add_u32 s35, s35, 512
  v_add_u32 v2, s35, v1
  v_mul_u32_u24 v3, 6554, v2
  v_lshrrev_b32 v3, 16, v3
  v_mul_u32_u24 v4, 10, v3
  v_sub_u32 v4, v2, v4
  v_mul_u32_u24 v3, 1280, v3
  v_lshl_add_u32 v3, v4, 4, v3
  v_lshlrev_b32 v2, 4, v2
  v_add_u32 v2, 153600, v2
  ds_read_b128 v[8:11], v2
  s_waitcnt lgkmcnt(0)
  buffer_store_dwordx4 v[8:11], v3, s[16:19], s34 offen
Lfe_80:
sequential_preLN__linear_kernel_hedgehog__glu_gated_reglu__prompt_kernel_end:
  s_endpgm
L_text_end:
  s_endpgm
.section .rodata,"a"
.p2align 6
.amdhsa_kernel sequential_preLN__linear_kernel_hedgehog__glu_gated_reglu__prompt_kernel
  .amdhsa_next_free_vgpr 256
  .amdhsa_next_free_sgpr 102
  .amdhsa_accum_offset 256
  .amdhsa_group_segment_fixed_size 0
  .amdhsa_kernarg_size 88
  .amdhsa_user_sgpr_count 2
  .amdhsa_user_sgpr_kernarg_segment_ptr 1
  .amdhsa_system_sgpr_workgroup_id_x 1
.end_amdhsa_kernel
```
